```python
import torch

def _softmax(x, axis=-1):
    return torch.softmax(x, dim=axis)
def _gelu(x):
    return torch.nn.functional.gelu(x, approximate="tanh")
def _silu(x):
    return torch.nn.functional.silu(x)
def _sigmoid(x):
    return torch.sigmoid(x)
def _layernorm(x, axis=-1, eps=1e-5):
    m = x.mean(dim=axis, keepdim=True)
    v = x.var(dim=axis, keepdim=True, unbiased=False)
    return (x - m) / torch.sqrt(v + eps)
def _scatter_add(tgt, idx, src, axis=0):
    return tgt.clone().index_add_(axis, idx, src)
def _segment_sum(src, seg, n):
    out = torch.zeros((n,) + src.shape[1:], dtype=src.dtype)
    return out.index_add_(0, seg, src)
def _pad(x, pw):
    flat = tuple(v for pair in reversed(pw) for v in pair)
    return torch.nn.functional.pad(x, flat)

kernel_name = 'standalone__softmax_full_bidir__prompt'

def setup_inputs():

    _w = (lambda a: (lambda t: t.to(torch.bfloat16) if t.is_floating_point() else t)(torch.as_tensor(a)))
    B, H, Sq, Skv, Dh = 1, 16, 2048, 2048, 256
    return {
        "q": _w((lambda *s: torch.randn(*s, dtype=torch.bfloat16) * 0.8)(B, H, Sq, Dh)),
        "k": _w((lambda *s: torch.randn(*s, dtype=torch.bfloat16) * 0.8)(B, H, Skv, Dh)),
        "v": _w((lambda *s: torch.randn(*s, dtype=torch.bfloat16) * 0.05)(B, H, Skv, Dh)),
    }

def reference(q, k, v):
    scale = q.shape[-1] ** -0.5
    scores = torch.einsum('bhqd,bhkd->bhqk', q, k) * scale
    attn = _softmax(scores, axis=-1)
    return torch.einsum('bhqk,bhkd->bhqd', attn, v)
```

```asm
; @launch grid=(256,1,1) block=(256,1,1) lds=163840
.amdgcn_target "amdgcn-amd-amdhsa--gfx950"
.set CODE_LAST, 24428
.set CODE_NPER, 6
.text
.globl standalone__softmax_full_bidir__prompt_kernel
.p2align 8
.type standalone__softmax_full_bidir__prompt_kernel,@function
standalone__softmax_full_bidir__prompt_kernel:
  s_cmp_ge_u32 s2, 256
  s_cbranch_scc1 L_end
  s_load_dwordx4 s[68:71], s[0:1], 0
  s_load_dwordx4 s[72:75], s[0:1], 16
  v_lshrrev_b32 v6, 6, v0
  v_and_b32 v11, 63, v0
  s_and_b32 s23, s2, 7
  v_readfirstlane_b32 s20, v6
  s_lshl_b32 s23, s23, 1
  s_lshr_b32 s24, s2, 7
  s_add_u32 s23, s23, s24
  s_lshr_b32 s24, s2, 3
  s_and_b32 s24, s24, 15
  s_and_b32 s21, s20, 1
  s_lshr_b32 s22, s20, 1
  s_lshl_b32 s78, s23, 20
  s_lshl_b32 s79, s22, 19
  s_add_u32 s78, s78, s79
  v_bfe_u32 v4, v11, 2, 3
  v_lshlrev_b32 v4, 9, v4
  v_lshrrev_b32 v8, 5, v11
  v_lshl_add_u32 v4, v8, 6, v4
  v_and_b32 v8, 3, v11
  v_lshrrev_b32 v9, 3, v11
  v_and_b32 v9, 2, v9
  v_xor_b32 v8, v8, v9
  v_lshl_add_u32 v4, v8, 4, v4
  s_lshl_b32 s79, s21, 8
  s_add_u32 s79, s79, s78
  v_add_u32 v4, s79, v4
  s_lshl_b32 s76, s24, 16
  s_lshl_b32 s77, s22, 15
  s_add_u32 s76, s76, s77
  s_lshl_b32 s77, s22, 19
  s_sub_u32 s76, s76, s77
  v_add_u32 v6, s76, v4
  s_mov_b32 s32, 2048
  s_mov_b32 s33, 5120
  s_mov_b32 s34, 128
  s_mov_b32 s35, 3200
  s_mov_b32 s36, 10240
  s_mov_b32 s37, 13312
  s_mov_b32 s38, 8320
  s_mov_b32 s39, 11392
  s_mov_b32 s40, 18432
  s_mov_b32 s41, 21504
  s_mov_b32 s42, 16512
  s_mov_b32 s43, 19584
  s_mov_b32 s44, 26624
  s_mov_b32 s45, 29696
  s_mov_b32 s46, 24704
  s_mov_b32 s47, 27776
  s_lshl_b32 s25, s22, 16
  s_lshl_b32 s76, s21, 12
  s_add_u32 s25, s25, s76
  s_waitcnt lgkmcnt(0)
  s_sub_u32 s8, s70, 2048
  s_subb_u32 s9, s71, 0
  s_mov_b32 s10, 0x1000800
  s_mov_b32 s11, 0x20000
  s_sub_u32 s4, s68, 2048
  s_subb_u32 s5, s69, 0
  s_mov_b32 s6, 0x1000800
  s_mov_b32 s7, 0x20000
  s_add_u32 m0, s25, 8192
  s_nop 0
  buffer_load_dwordx4 v6, s[4:7], s32 offen offset:0 nt lds
  buffer_load_dwordx4 v6, s[4:7], s33 offen offset:1024 nt lds
  buffer_load_dwordx4 v6, s[4:7], s34 offen offset:2048 nt lds
  buffer_load_dwordx4 v6, s[4:7], s35 offen offset:3072 nt lds
  s_add_u32 m0, s25, 0
  s_nop 0
  buffer_load_dwordx4 v4, s[8:11], s32 offen offset:0 lds
  buffer_load_dwordx4 v4, s[8:11], s33 offen offset:1024 lds
  buffer_load_dwordx4 v4, s[8:11], s34 offen offset:2048 lds
  buffer_load_dwordx4 v4, s[8:11], s35 offen offset:3072 lds
  s_getpc_b64 s[76:77]
L_pc:
  s_sub_u32 s76, s76, L_pc-standalone__softmax_full_bidir__prompt_kernel
  s_subb_u32 s77, s77, 0
  s_lshr_b32 s78, s2, 3
  s_mul_i32 s78, s78, CODE_NPER
  v_add_u32 v126, s78, v11
  v_lshlrev_b32 v126, 7, v126
  v_min_u32 v126, CODE_LAST, v126
  v_cmp_gt_u32 vcc, CODE_NPER, v11
  s_mov_b64 s[78:79], exec
  s_and_b64 exec, exec, vcc
  global_load_dword v127, v126, s[76:77]
  s_mov_b64 exec, s[78:79]
  s_mov_b32 s12, s72
  s_mov_b32 s13, s73
  s_mov_b32 s14, 0x1000000
  s_mov_b32 s15, 0x20000
  s_lshl_b32 s78, s23, 20
  s_lshl_b32 s79, s22, 19
  s_add_u32 s78, s78, s79
  v_bfe_u32 v5, v11, 2, 2
  v_lshlrev_b32 v5, 10, v5
  v_bfe_u32 v8, v11, 4, 1
  v_lshl_add_u32 v5, v8, 9, v5
  v_lshlrev_b32 v8, 1, v8
  v_and_b32 v9, 3, v11
  v_xor_b32 v9, v9, v8
  v_lshl_add_u32 v5, v9, 4, v5
  v_lshrrev_b32 v8, 5, v11
  v_lshl_add_u32 v5, v8, 6, v5
  s_lshl_b32 s79, s21, 14
  s_add_u32 s79, s79, s78
  v_add_u32 v5, s79, v5
  v_bfe_u32 v1, v11, 3, 1
  v_lshlrev_b32 v1, 10, v1
  v_and_b32 v8, 7, v11
  v_lshl_add_u32 v1, v8, 6, v1
  v_lshrrev_b32 v8, 4, v11
  v_lshrrev_b32 v9, 1, v11
  v_and_b32 v9, 2, v9
  v_xor_b32 v8, v8, v9
  v_lshl_add_u32 v1, v8, 4, v1
  s_lshl_b32 s78, s22, 16
  v_lshrrev_b32 v2, 5, v11
  v_lshlrev_b32 v2, 10, v2
  v_bfe_u32 v8, v11, 2, 1
  v_lshl_add_u32 v2, v8, 8, v2
  v_bfe_u32 v9, v11, 4, 1
  v_lshl_add_u32 v2, v9, 7, v2
  v_bfe_u32 v9, v11, 3, 1
  v_lshl_add_u32 v2, v9, 6, v2
  v_bfe_u32 v9, v11, 1, 1
  v_lshlrev_b32 v8, 1, v8
  v_xor_b32 v9, v9, v8
  v_lshl_add_u32 v2, v9, 4, v2
  v_and_b32 v9, 1, v11
  v_lshl_add_u32 v2, v9, 3, v2
  v_add_u32 v2, s78, v2
  v_xor_b32 v3, 32, v2
  s_lshl_b32 s76, s21, 16
  v_add_u32 v7, s76, v1
  s_lshl_b32 s76, s22, 16
  v_add_u32 v1, s76, v1
  s_mov_b32 s28, 0x3db8aa3b
  s_mov_b32 s29, 0x3db8aa3b
  s_lshl_b32 s76, s22, 8
  s_xor_b32 s77, s76, 256
  s_add_u32 s48, s77, 0
  s_add_u32 s49, s77, 3072
  s_add_u32 s50, s77, 6144
  s_add_u32 s51, s77, 9216
  s_xor_b32 s77, s76, 384
  s_add_u32 s52, s77, 0
  s_add_u32 s53, s77, 3072
  s_add_u32 s54, s77, 6144
  s_add_u32 s55, s77, 9216
  s_xor_b32 s77, s76, 0
  s_add_u32 s56, s77, 0
  s_add_u32 s57, s77, 3072
  s_add_u32 s58, s77, 6144
  s_add_u32 s59, s77, 9216
  s_xor_b32 s77, s76, 128
  s_add_u32 s60, s77, 0
  s_add_u32 s61, s77, 3072
  s_add_u32 s62, s77, 6144
  s_add_u32 s63, s77, 9216
  s_mov_b32 s64, 0
  s_mov_b32 s65, 8192
  s_mov_b32 s66, 16384
  s_mov_b32 s67, 24576
  s_mov_b32 s27, 0
  v_mov_b32 v12, 0
  v_mov_b32 v13, 0
  v_mov_b32 v14, 0
  v_mov_b32 v15, 0
  s_add_u32 m0, s25, 24576
  s_nop 0
  buffer_load_dwordx4 v6, s[4:7], s36 offen offset:0 nt lds
  buffer_load_dwordx4 v6, s[4:7], s37 offen offset:1024 nt lds
  buffer_load_dwordx4 v6, s[4:7], s38 offen offset:2048 nt lds
  buffer_load_dwordx4 v6, s[4:7], s39 offen offset:3072 nt lds
  s_add_u32 m0, s25, 16384
  s_nop 0
  buffer_load_dwordx4 v4, s[8:11], s36 offen offset:0 lds
  buffer_load_dwordx4 v4, s[8:11], s37 offen offset:1024 lds
  buffer_load_dwordx4 v4, s[8:11], s38 offen offset:2048 lds
  buffer_load_dwordx4 v4, s[8:11], s39 offen offset:3072 lds
  v_and_b32 v11, 63, v0
  v_bfe_u32 v8, v11, 2, 2
  v_lshrrev_b32 v9, 4, v11
  v_cmp_eq_u32 vcc, v8, v9
  v_and_b32 v8, 1, v11
  v_lshlrev_b32 v8, 4, v8
  v_mov_b32 v9, 0x3db9
  v_lshlrev_b32 v9, v8, v9
  v_cndmask_b32 v9, 0, v9, vcc
  v_mov_b32 v10, 0xb92c
  v_lshlrev_b32 v10, v8, v10
  v_cndmask_b32 v10, 0, v10, vcc
  v_bfe_u32 v8, v11, 1, 1
  v_cmp_eq_u32 vcc, 0, v8
  s_nop 0
  v_mov_b32 v16, 0
  v_mov_b32 v17, 0
  v_mov_b32 v18, 0
  v_mov_b32 v19, 0
  v_mov_b32 v20, 0
  v_mov_b32 v21, 0
  v_mov_b32 v22, 0
  v_mov_b32 v23, 0
  v_mov_b32 v24, 0
  v_mov_b32 v25, 0
  v_mov_b32 v26, 0
  v_mov_b32 v27, 0
  v_mov_b32 v28, 0
  v_mov_b32 v29, 0
  v_mov_b32 v30, 0
  v_mov_b32 v31, 0
  v_cndmask_b32 v16, 0, v9, vcc
  v_cndmask_b32 v17, v9, 0, vcc
  v_cndmask_b32 v20, 0, v10, vcc
  v_cndmask_b32 v21, v10, 0, vcc
  v_cndmask_b32 v26, 0, v9, vcc
  v_cndmask_b32 v27, v9, 0, vcc
  v_cndmask_b32 v30, 0, v10, vcc
  v_cndmask_b32 v31, v10, 0, vcc
  s_waitcnt vmcnt(9)
  s_barrier
  ds_read_b128 v[80:83], v7 offset:8192
  ds_read_b128 v[84:87], v7 offset:8704
  ds_read_b128 v[88:91], v7 offset:10240
  ds_read_b128 v[92:95], v7 offset:10752
  ds_read_b128 v[96:99], v7 offset:12288
  ds_read_b128 v[100:103], v7 offset:12800
  ds_read_b128 v[104:107], v7 offset:14336
  ds_read_b128 v[108:111], v7 offset:14848
  s_waitcnt lgkmcnt(4)
  v_mfma_f32_16x16x32_bf16 v[32:35], v[16:19], v[80:83], 0
  s_add_u32 m0, s25, 32768
  v_mfma_f32_16x16x32_bf16 v[32:35], v[20:23], v[80:83], v[32:35]
  buffer_load_dwordx4 v4, s[8:11], s40 offen offset:0 lds
  v_mfma_f32_16x16x32_bf16 v[36:39], v[24:27], v[80:83], 0
  buffer_load_dwordx4 v4, s[8:11], s41 offen offset:1024 lds
  v_mfma_f32_16x16x32_bf16 v[36:39], v[28:31], v[80:83], v[36:39]
  buffer_load_dwordx4 v4, s[8:11], s42 offen offset:2048 lds
  v_mfma_f32_16x16x32_bf16 v[40:43], v[16:19], v[84:87], 0
  buffer_load_dwordx4 v4, s[8:11], s43 offen offset:3072 lds
  ds_read_b128 v[128:131], v1 offset:0
  v_mfma_f32_16x16x32_bf16 v[40:43], v[20:23], v[84:87], v[40:43]
  ds_read_b128 v[132:135], v1 offset:512
  v_mfma_f32_16x16x32_bf16 v[44:47], v[24:27], v[84:87], 0
  ds_read_b128 v[136:139], v1 offset:2048
  v_mfma_f32_16x16x32_bf16 v[44:47], v[28:31], v[84:87], v[44:47]
  s_add_u32 m0, s25, 49152
  ds_read_b128 v[140:143], v1 offset:2560
  v_mfma_f32_16x16x32_bf16 v[48:51], v[16:19], v[88:91], 0
  buffer_load_dwordx4 v4, s[8:11], s44 offen offset:0 lds
  ds_read_b128 v[144:147], v1 offset:4096
  v_mfma_f32_16x16x32_bf16 v[48:51], v[20:23], v[88:91], v[48:51]
  buffer_load_dwordx4 v4, s[8:11], s45 offen offset:1024 lds
  v_cvt_pk_bf16_f32 v32, v32, v33
  v_mfma_f32_16x16x32_bf16 v[52:55], v[24:27], v[88:91], 0
  buffer_load_dwordx4 v4, s[8:11], s46 offen offset:2048 lds
  v_cvt_pk_bf16_f32 v34, v34, v35
  v_mfma_f32_16x16x32_bf16 v[52:55], v[28:31], v[88:91], v[52:55]
  buffer_load_dwordx4 v4, s[8:11], s47 offen offset:3072 lds
  v_cvt_pk_bf16_f32 v36, v36, v37
  v_mfma_f32_16x16x32_bf16 v[56:59], v[16:19], v[92:95], 0
  v_cvt_pk_bf16_f32 v38, v38, v39
  v_accvgpr_write_b32 a0, v32
  v_mfma_f32_16x16x32_bf16 v[56:59], v[20:23], v[92:95], v[56:59]
  v_accvgpr_write_b32 a1, v34
  v_accvgpr_write_b32 a2, v36
  v_mfma_f32_16x16x32_bf16 v[60:63], v[24:27], v[92:95], 0
  v_accvgpr_write_b32 a3, v38
  s_add_u32 m0, s25, 40960
  v_mfma_f32_16x16x32_bf16 v[60:63], v[28:31], v[92:95], v[60:63]
  buffer_load_dwordx4 v6, s[4:7], s40 offen offset:0 nt lds
  s_waitcnt lgkmcnt(5)
  v_mfma_f32_16x16x32_bf16 v[32:35], v[16:19], v[96:99], 0
  buffer_load_dwordx4 v6, s[4:7], s41 offen offset:1024 nt lds
  v_cvt_pk_bf16_f32 v40, v40, v41
  v_mfma_f32_16x16x32_bf16 v[32:35], v[20:23], v[96:99], v[32:35]
  buffer_load_dwordx4 v6, s[4:7], s42 offen offset:2048 nt lds
  v_cvt_pk_bf16_f32 v42, v42, v43
  v_mfma_f32_16x16x32_bf16 v[36:39], v[24:27], v[96:99], 0
  v_cvt_pk_bf16_f32 v44, v44, v45
  v_cvt_pk_bf16_f32 v46, v46, v47
  v_mfma_f32_16x16x32_bf16 v[36:39], v[28:31], v[96:99], v[36:39]
  v_accvgpr_write_b32 a4, v40
  v_accvgpr_write_b32 a5, v42
  v_accvgpr_write_b32 a6, v44
  v_accvgpr_write_b32 a7, v46
  v_mfma_f32_16x16x32_bf16 v[40:43], v[16:19], v[100:103], 0
  buffer_load_dwordx4 v6, s[4:7], s43 offen offset:3072 nt lds
  v_cvt_pk_bf16_f32 v48, v48, v49
  v_mfma_f32_16x16x32_bf16 v[40:43], v[20:23], v[100:103], v[40:43]
  s_add_u32 m0, s25, 57344
  v_cvt_pk_bf16_f32 v50, v50, v51
  v_mfma_f32_16x16x32_bf16 v[44:47], v[24:27], v[100:103], 0
  v_cvt_pk_bf16_f32 v52, v52, v53
  v_cvt_pk_bf16_f32 v54, v54, v55
  v_mfma_f32_16x16x32_bf16 v[44:47], v[28:31], v[100:103], v[44:47]
  v_accvgpr_write_b32 a8, v48
  v_accvgpr_write_b32 a9, v50
  v_accvgpr_write_b32 a10, v52
  v_accvgpr_write_b32 a11, v54
  v_mfma_f32_16x16x32_bf16 v[48:51], v[16:19], v[104:107], 0
  buffer_load_dwordx4 v6, s[4:7], s44 offen offset:0 nt lds
  buffer_load_dwordx4 v6, s[4:7], s45 offen offset:1024 nt lds
  v_mfma_f32_16x16x32_bf16 v[48:51], v[20:23], v[104:107], v[48:51]
  buffer_load_dwordx4 v6, s[4:7], s46 offen offset:2048 nt lds
  buffer_load_dwordx4 v6, s[4:7], s47 offen offset:3072 nt lds
  v_mfma_f32_16x16x32_bf16 v[52:55], v[24:27], v[104:107], 0
  v_cvt_pk_bf16_f32 v56, v56, v57
  v_cvt_pk_bf16_f32 v58, v58, v59
  v_mfma_f32_16x16x32_bf16 v[52:55], v[28:31], v[104:107], v[52:55]
  v_cvt_pk_bf16_f32 v60, v60, v61
  v_cvt_pk_bf16_f32 v62, v62, v63
  v_accvgpr_write_b32 a12, v56
  v_accvgpr_write_b32 a13, v58
  v_accvgpr_write_b32 a14, v60
  v_accvgpr_write_b32 a15, v62
  v_mfma_f32_16x16x32_bf16 v[56:59], v[16:19], v[108:111], 0
  ds_read_b128 v[148:151], v1 offset:4608
  ds_read_b128 v[152:155], v1 offset:6144
  v_mfma_f32_16x16x32_bf16 v[56:59], v[20:23], v[108:111], v[56:59]
  ds_read_b128 v[156:159], v1 offset:6656
  v_cvt_pk_bf16_f32 v32, v32, v33
  v_mfma_f32_16x16x32_bf16 v[60:63], v[24:27], v[108:111], 0
  v_cvt_pk_bf16_f32 v34, v34, v35
  v_cvt_pk_bf16_f32 v36, v36, v37
  v_mfma_f32_16x16x32_bf16 v[60:63], v[28:31], v[108:111], v[60:63]
  v_cvt_pk_bf16_f32 v38, v38, v39
  s_waitcnt vmcnt(8)
  s_barrier
  ds_read_b128 v[80:83], v7 offset:24576
  ds_read_b128 v[84:87], v7 offset:25088
  ds_read_b128 v[88:91], v7 offset:26624
  ds_read_b128 v[92:95], v7 offset:27136
  ds_read_b128 v[96:99], v7 offset:28672
  ds_read_b128 v[100:103], v7 offset:29184
  ds_read_b128 v[104:107], v7 offset:30720
  s_waitcnt lgkmcnt(10)
  ds_read_b128 v[108:111], v7 offset:31232
  s_waitcnt lgkmcnt(8)
  v_mfma_f32_16x16x32_bf16 v[112:115], v[128:131], a[0:3], 0
  v_accvgpr_write_b32 a16, v32
  v_accvgpr_write_b32 a17, v34
  v_mfma_f32_16x16x32_bf16 v[112:115], v[132:135], a[4:7], v[112:115]
  v_accvgpr_write_b32 a18, v36
  v_accvgpr_write_b32 a19, v38
  v_mfma_f32_16x16x32_bf16 v[112:115], v[136:139], a[8:11], v[112:115]
  v_cvt_pk_bf16_f32 v40, v40, v41
  v_cvt_pk_bf16_f32 v42, v42, v43
  v_mfma_f32_16x16x32_bf16 v[112:115], v[140:143], a[12:15], v[112:115]
  v_cvt_pk_bf16_f32 v44, v44, v45
  v_cvt_pk_bf16_f32 v46, v46, v47
  v_accvgpr_write_b32 a20, v40
  v_accvgpr_write_b32 a21, v42
  v_accvgpr_write_b32 a22, v44
  v_accvgpr_write_b32 a23, v46
  v_mfma_f32_16x16x32_bf16 v[112:115], v[144:147], a[16:19], v[112:115]
  v_cvt_pk_bf16_f32 v48, v48, v49
  v_cvt_pk_bf16_f32 v50, v50, v51
  v_cvt_pk_bf16_f32 v52, v52, v53
  v_cvt_pk_bf16_f32 v54, v54, v55
  v_accvgpr_write_b32 a24, v48
  v_accvgpr_write_b32 a25, v50
  v_accvgpr_write_b32 a26, v52
  v_accvgpr_write_b32 a27, v54
  v_mfma_f32_16x16x32_bf16 v[112:115], v[148:151], a[20:23], v[112:115]
  v_cvt_pk_bf16_f32 v56, v56, v57
  v_cvt_pk_bf16_f32 v58, v58, v59
  v_cvt_pk_bf16_f32 v60, v60, v61
  v_cvt_pk_bf16_f32 v62, v62, v63
  v_accvgpr_write_b32 a28, v56
  v_accvgpr_write_b32 a29, v58
  v_accvgpr_write_b32 a30, v60
  v_accvgpr_write_b32 a31, v62
  v_mfma_f32_16x16x32_bf16 v[112:115], v[152:155], a[24:27], v[112:115]
  s_nop 1
  v_mfma_f32_16x16x32_bf16 v[112:115], v[156:159], a[28:31], v[112:115]
  ds_read_b128 v[160:163], v1 offset:16384
  s_waitcnt lgkmcnt(5)
  v_mfma_f32_16x16x32_bf16 v[32:35], v[16:19], v[80:83], 0
  ds_read_b128 v[164:167], v1 offset:16896
  ds_read_b128 v[168:171], v1 offset:18432
  v_mfma_f32_16x16x32_bf16 v[32:35], v[20:23], v[80:83], v[32:35]
  ds_read_b128 v[172:175], v1 offset:18944
  ds_read_b128 v[176:179], v1 offset:20480
  v_mfma_f32_16x16x32_bf16 v[36:39], v[24:27], v[80:83], 0
  ds_read_b128 v[180:183], v1 offset:20992
  ds_read_b128 v[184:187], v1 offset:22528
  v_mfma_f32_16x16x32_bf16 v[36:39], v[28:31], v[80:83], v[36:39]
  ds_read_b128 v[188:191], v1 offset:23040
  v_add_u32 v4, 0x8000, v4
  v_mfma_f32_16x16x32_bf16 v[40:43], v[16:19], v[84:87], 0
  s_add_u32 m0, s25, 8192
  ds_read_b128 v[192:195], v1 offset:32768
  v_mfma_f32_16x16x32_bf16 v[40:43], v[20:23], v[84:87], v[40:43]
  buffer_load_dwordx4 v5, s[12:15], s48 offen offset:0 lds
  ds_read_b128 v[196:199], v1 offset:33280
  v_mfma_f32_16x16x32_bf16 v[44:47], v[24:27], v[84:87], 0
  ds_read_b128 v[200:203], v1 offset:34816
  s_waitcnt lgkmcnt(10)
  ds_read_b128 v[204:207], v1 offset:35328
  v_mfma_f32_16x16x32_bf16 v[44:47], v[28:31], v[84:87], v[44:47]
  buffer_load_dwordx4 v5, s[12:15], s49 offen offset:1024 lds
  s_waitcnt lgkmcnt(4)
  v_mfma_f32_16x16x32_bf16 v[116:119], v[160:163], a[0:3], 0
  ds_read_b128 v[208:211], v1 offset:36864
  ds_read_b128 v[212:215], v1 offset:37376
  v_mfma_f32_16x16x32_bf16 v[116:119], v[164:167], a[4:7], v[116:119]
  buffer_load_dwordx4 v5, s[12:15], s50 offen offset:2048 lds
  v_cvt_pk_bf16_f32 v32, v32, v33
  v_mfma_f32_16x16x32_bf16 v[116:119], v[168:171], a[8:11], v[116:119]
  v_cvt_pk_bf16_f32 v34, v34, v35
  v_cvt_pk_bf16_f32 v36, v36, v37
  v_mfma_f32_16x16x32_bf16 v[116:119], v[172:175], a[12:15], v[116:119]
  buffer_load_dwordx4 v5, s[12:15], s51 offen offset:3072 lds
  v_cvt_pk_bf16_f32 v38, v38, v39
  v_mfma_f32_16x16x32_bf16 v[116:119], v[176:179], a[16:19], v[116:119]
  v_accvgpr_write_b32 a32, v32
  v_accvgpr_write_b32 a33, v34
  v_mfma_f32_16x16x32_bf16 v[116:119], v[180:183], a[20:23], v[116:119]
  v_accvgpr_write_b32 a34, v36
  v_accvgpr_write_b32 a35, v38
  v_mfma_f32_16x16x32_bf16 v[116:119], v[184:187], a[24:27], v[116:119]
  v_cvt_pk_bf16_f32 v40, v40, v41
  v_cvt_pk_bf16_f32 v42, v42, v43
  v_mfma_f32_16x16x32_bf16 v[116:119], v[188:191], a[28:31], v[116:119]
  v_cvt_pk_bf16_f32 v44, v44, v45
  v_cvt_pk_bf16_f32 v46, v46, v47
  v_mfma_f32_16x16x32_bf16 v[32:35], v[16:19], v[88:91], 0
  v_accvgpr_write_b32 a36, v40
  v_accvgpr_write_b32 a37, v42
  v_mfma_f32_16x16x32_bf16 v[32:35], v[20:23], v[88:91], v[32:35]
  v_accvgpr_write_b32 a38, v44
  v_accvgpr_write_b32 a39, v46
  v_mfma_f32_16x16x32_bf16 v[36:39], v[24:27], v[88:91], 0
  ds_read_b128 v[216:219], v1 offset:38912
  ds_read_b128 v[220:223], v1 offset:39424
  v_mfma_f32_16x16x32_bf16 v[36:39], v[28:31], v[88:91], v[36:39]
  ds_read_b128 v[224:227], v1 offset:49152
  ds_read_b128 v[228:231], v1 offset:49664
  v_mfma_f32_16x16x32_bf16 v[40:43], v[16:19], v[92:95], 0
  ds_read_b128 v[232:235], v1 offset:51200
  ds_read_b128 v[236:239], v1 offset:51712
  v_mfma_f32_16x16x32_bf16 v[40:43], v[20:23], v[92:95], v[40:43]
  ds_read_b128 v[240:243], v1 offset:53248
  ds_read_b128 v[244:247], v1 offset:53760
  v_mfma_f32_16x16x32_bf16 v[44:47], v[24:27], v[92:95], 0
  ds_read_b128 v[248:251], v1 offset:55296
  s_waitcnt lgkmcnt(10)
  ds_read_b128 v[252:255], v1 offset:55808
  v_mfma_f32_16x16x32_bf16 v[44:47], v[28:31], v[92:95], v[44:47]
  s_waitcnt lgkmcnt(8)
  v_mfma_f32_16x16x32_bf16 v[120:123], v[192:195], a[0:3], 0
  v_exp_f32 v8, v112
  v_mfma_f32_16x16x32_bf16 v[120:123], v[196:199], a[4:7], v[120:123]
  v_cvt_pk_bf16_f32 v32, v32, v33
  v_cvt_pk_bf16_f32 v34, v34, v35
  v_mfma_f32_16x16x32_bf16 v[120:123], v[200:203], a[8:11], v[120:123]
  v_cvt_pk_bf16_f32 v36, v36, v37
  v_cvt_pk_bf16_f32 v38, v38, v39
  v_mfma_f32_16x16x32_bf16 v[120:123], v[204:207], a[12:15], v[120:123]
  v_accvgpr_write_b32 a40, v32
  v_accvgpr_write_b32 a41, v34
  v_mfma_f32_16x16x32_bf16 v[120:123], v[208:211], a[16:19], v[120:123]
  v_accvgpr_write_b32 a42, v36
  v_accvgpr_write_b32 a43, v38
  v_mfma_f32_16x16x32_bf16 v[120:123], v[212:215], a[20:23], v[120:123]
  v_cvt_pk_bf16_f32 v40, v40, v41
  v_cvt_pk_bf16_f32 v42, v42, v43
  v_mfma_f32_16x16x32_bf16 v[120:123], v[216:219], a[24:27], v[120:123]
  v_cvt_pk_bf16_f32 v44, v44, v45
  v_cvt_pk_bf16_f32 v46, v46, v47
  v_mfma_f32_16x16x32_bf16 v[120:123], v[220:223], a[28:31], v[120:123]
  v_accvgpr_write_b32 a44, v40
  v_mfma_f32_16x16x32_bf16 v[32:35], v[16:19], v[96:99], 0
  v_accvgpr_write_b32 a45, v42
  v_accvgpr_write_b32 a46, v44
  v_mfma_f32_16x16x32_bf16 v[32:35], v[20:23], v[96:99], v[32:35]
  v_accvgpr_write_b32 a47, v46
  v_mfma_f32_16x16x32_bf16 v[36:39], v[24:27], v[96:99], 0
  v_exp_f32 v9, v113
  v_mfma_f32_16x16x32_bf16 v[36:39], v[28:31], v[96:99], v[36:39]
  v_add_f32 v12, v12, v8
  v_cvt_pk_bf16_f32 v48, v8, v9
  v_mfma_f32_16x16x32_bf16 v[40:43], v[16:19], v[100:103], 0
  v_add_f32 v12, v12, v9
  v_mfma_f32_16x16x32_bf16 v[40:43], v[20:23], v[100:103], v[40:43]
  v_exp_f32 v10, v114
  v_mfma_f32_16x16x32_bf16 v[44:47], v[24:27], v[100:103], 0
  v_exp_f32 v11, v115
  v_mfma_f32_16x16x32_bf16 v[44:47], v[28:31], v[100:103], v[44:47]
  v_add_f32 v12, v12, v10
  s_waitcnt lgkmcnt(0)
  v_mfma_f32_16x16x32_bf16 v[124:127], v[224:227], a[0:3], 0
  v_cvt_pk_bf16_f32 v49, v10, v11
  v_add_f32 v12, v12, v11
  v_mfma_f32_16x16x32_bf16 v[124:127], v[228:231], a[4:7], v[124:127]
  v_cvt_pk_bf16_f32 v32, v32, v33
  v_cvt_pk_bf16_f32 v34, v34, v35
  v_mfma_f32_16x16x32_bf16 v[124:127], v[232:235], a[8:11], v[124:127]
  v_cvt_pk_bf16_f32 v36, v36, v37
  v_cvt_pk_bf16_f32 v38, v38, v39
  v_mfma_f32_16x16x32_bf16 v[124:127], v[236:239], a[12:15], v[124:127]
  v_accvgpr_write_b32 a48, v32
  v_accvgpr_write_b32 a49, v34
  v_mfma_f32_16x16x32_bf16 v[124:127], v[240:243], a[16:19], v[124:127]
  v_accvgpr_write_b32 a50, v36
  v_accvgpr_write_b32 a51, v38
  v_mfma_f32_16x16x32_bf16 v[124:127], v[244:247], a[20:23], v[124:127]
  v_cvt_pk_bf16_f32 v40, v40, v41
  v_cvt_pk_bf16_f32 v42, v42, v43
  v_mfma_f32_16x16x32_bf16 v[124:127], v[248:251], a[24:27], v[124:127]
  v_cvt_pk_bf16_f32 v44, v44, v45
  v_cvt_pk_bf16_f32 v46, v46, v47
  v_mfma_f32_16x16x32_bf16 v[124:127], v[252:255], a[28:31], v[124:127]
  v_accvgpr_write_b32 a52, v40
  v_accvgpr_write_b32 a53, v42
  v_mfma_f32_16x16x32_bf16 v[32:35], v[16:19], v[104:107], 0
  v_accvgpr_write_b32 a54, v44
  v_accvgpr_write_b32 a55, v46
  v_mfma_f32_16x16x32_bf16 v[32:35], v[20:23], v[104:107], v[32:35]
  v_exp_f32 v8, v116
  v_mfma_f32_16x16x32_bf16 v[36:39], v[24:27], v[104:107], 0
  v_exp_f32 v9, v117
  v_mfma_f32_16x16x32_bf16 v[36:39], v[28:31], v[104:107], v[36:39]
  v_add_f32 v12, v12, v8
  v_cvt_pk_bf16_f32 v50, v8, v9
  v_mfma_f32_16x16x32_bf16 v[40:43], v[16:19], v[108:111], 0
  v_add_f32 v12, v12, v9
  v_mfma_f32_16x16x32_bf16 v[40:43], v[20:23], v[108:111], v[40:43]
  v_exp_f32 v10, v118
  v_mfma_f32_16x16x32_bf16 v[44:47], v[24:27], v[108:111], 0
  v_exp_f32 v11, v119
  v_mfma_f32_16x16x32_bf16 v[44:47], v[28:31], v[108:111], v[44:47]
  v_add_f32 v12, v12, v10
  v_cvt_pk_bf16_f32 v51, v10, v11
  s_cmp_eq_u32 s21, 0
  s_cselect_b32 s4, s70, s72
  s_cselect_b32 s5, s71, s73
  s_mov_b32 s6, 0x1000000
  s_mov_b32 s7, 0x20000
  s_mov_b32 s16, s74
  s_mov_b32 s17, s75
  s_mov_b32 s18, 0x1000000
  s_mov_b32 s19, 0x20000
  s_lshl_b32 s76, s22, 16
  s_xor_b32 s77, s76, 0x10000
  s_lshl_b32 s78, s21, 15
  s_add_u32 s68, s76, s78
  s_add_u32 s69, s77, s78
  s_lshl_b32 s79, s22, 14
  s_add_u32 s79, s79, 131072
  s_xor_b32 s75, s79, 0x4000
  s_add_u32 s76, s76, 8192
  s_add_u32 s77, s77, 8192
  s_cmp_eq_u32 s21, 0
  s_cselect_b32 s70, s76, s79
  s_cselect_b32 s71, s77, s75
  s_cselect_b32 s72, 4, 1
  s_lshl_b32 s72, s72, 13
  s_lshl_b32 s73, s21, 9
  s_lshl_b32 s76, s22, 8
  s_add_u32 s73, s73, s76
  s_add_u32 s73, s73, 131072
  s_lshl_b32 s74, s23, 20
  s_lshl_b32 s76, s24, 16
  s_add_u32 s74, s74, s76
  s_add_u32 s74, s74, s78
  s_lshl_b32 s76, s22, 8
  s_add_u32 s74, s74, s76
  s_waitcnt vmcnt(8)
  s_barrier
  ds_read_b128 v[80:83], v7 offset:40960
  ds_read_b128 v[84:87], v7 offset:41472
  ds_read_b128 v[88:91], v7 offset:43008
  ds_read_b128 v[92:95], v7 offset:43520
  ds_read_b128 v[96:99], v7 offset:45056
  ds_read_b128 v[100:103], v7 offset:45568
  ds_read_b128 v[104:107], v7 offset:47104
  ds_read_b128 v[108:111], v7 offset:47616
  v_mfma_f32_16x16x32_bf16 v[112:115], v[128:131], a[32:35], 0
  v_add_f32 v12, v12, v11
  v_mfma_f32_16x16x32_bf16 v[112:115], v[132:135], a[36:39], v[112:115]
  v_cvt_pk_bf16_f32 v32, v32, v33
  v_cvt_pk_bf16_f32 v34, v34, v35
  v_mfma_f32_16x16x32_bf16 v[112:115], v[136:139], a[40:43], v[112:115]
  v_cvt_pk_bf16_f32 v36, v36, v37
  v_cvt_pk_bf16_f32 v38, v38, v39
  v_mfma_f32_16x16x32_bf16 v[112:115], v[140:143], a[44:47], v[112:115]
  v_accvgpr_write_b32 a56, v32
  v_accvgpr_write_b32 a57, v34
  v_mfma_f32_16x16x32_bf16 v[112:115], v[144:147], a[48:51], v[112:115]
  v_accvgpr_write_b32 a58, v36
  v_accvgpr_write_b32 a59, v38
  v_mfma_f32_16x16x32_bf16 v[112:115], v[148:151], a[52:55], v[112:115]
  v_cvt_pk_bf16_f32 v40, v40, v41
  v_cvt_pk_bf16_f32 v42, v42, v43
  v_cvt_pk_bf16_f32 v44, v44, v45
  v_cvt_pk_bf16_f32 v46, v46, v47
  v_accvgpr_write_b32 a60, v40
  v_accvgpr_write_b32 a61, v42
  v_accvgpr_write_b32 a62, v44
  v_accvgpr_write_b32 a63, v46
  v_mfma_f32_16x16x32_bf16 v[112:115], v[152:155], a[56:59], v[112:115]
  s_nop 1
  v_mfma_f32_16x16x32_bf16 v[112:115], v[156:159], a[60:63], v[112:115]
  s_waitcnt lgkmcnt(4)
  v_mfma_f32_16x16x32_bf16 v[32:35], v[16:19], v[80:83], 0
  v_exp_f32 v8, v120
  v_mfma_f32_16x16x32_bf16 v[32:35], v[20:23], v[80:83], v[32:35]
  v_exp_f32 v9, v121
  v_mfma_f32_16x16x32_bf16 v[36:39], v[24:27], v[80:83], 0
  v_add_f32 v12, v12, v8
  v_cvt_pk_bf16_f32 v52, v8, v9
  v_mfma_f32_16x16x32_bf16 v[36:39], v[28:31], v[80:83], v[36:39]
  v_add_f32 v12, v12, v9
  v_mfma_f32_16x16x32_bf16 v[40:43], v[16:19], v[84:87], 0
  v_exp_f32 v10, v122
  v_mfma_f32_16x16x32_bf16 v[40:43], v[20:23], v[84:87], v[40:43]
  v_exp_f32 v11, v123
  v_mfma_f32_16x16x32_bf16 v[44:47], v[24:27], v[84:87], 0
  v_add_f32 v12, v12, v10
  v_cvt_pk_bf16_f32 v53, v10, v11
  v_mfma_f32_16x16x32_bf16 v[44:47], v[28:31], v[84:87], v[44:47]
  v_add_f32 v12, v12, v11
  v_mfma_f32_16x16x32_bf16 v[116:119], v[160:163], a[32:35], 0
  v_exp_f32 v8, v124
  v_mfma_f32_16x16x32_bf16 v[116:119], v[164:167], a[36:39], v[116:119]
  v_cvt_pk_bf16_f32 v32, v32, v33
  v_cvt_pk_bf16_f32 v34, v34, v35
  v_mfma_f32_16x16x32_bf16 v[116:119], v[168:171], a[40:43], v[116:119]
  v_cvt_pk_bf16_f32 v36, v36, v37
  v_cvt_pk_bf16_f32 v38, v38, v39
  v_mfma_f32_16x16x32_bf16 v[116:119], v[172:175], a[44:47], v[116:119]
  v_accvgpr_write_b32 a64, v32
  v_accvgpr_write_b32 a65, v34
  v_mfma_f32_16x16x32_bf16 v[116:119], v[176:179], a[48:51], v[116:119]
  v_accvgpr_write_b32 a66, v36
  v_accvgpr_write_b32 a67, v38
  v_mfma_f32_16x16x32_bf16 v[116:119], v[180:183], a[52:55], v[116:119]
  v_cvt_pk_bf16_f32 v40, v40, v41
  v_cvt_pk_bf16_f32 v42, v42, v43
  v_mfma_f32_16x16x32_bf16 v[116:119], v[184:187], a[56:59], v[116:119]
  v_cvt_pk_bf16_f32 v44, v44, v45
  v_cvt_pk_bf16_f32 v46, v46, v47
  v_mfma_f32_16x16x32_bf16 v[116:119], v[188:191], a[60:63], v[116:119]
  v_accvgpr_write_b32 a68, v40
  v_accvgpr_write_b32 a69, v42
  v_mfma_f32_16x16x32_bf16 v[32:35], v[16:19], v[88:91], 0
  v_accvgpr_write_b32 a70, v44
  v_accvgpr_write_b32 a71, v46
  v_mfma_f32_16x16x32_bf16 v[32:35], v[20:23], v[88:91], v[32:35]
  v_exp_f32 v9, v125
  v_mfma_f32_16x16x32_bf16 v[36:39], v[24:27], v[88:91], 0
  v_add_f32 v12, v12, v8
  v_cvt_pk_bf16_f32 v54, v8, v9
  v_mfma_f32_16x16x32_bf16 v[36:39], v[28:31], v[88:91], v[36:39]
  v_add_f32 v12, v12, v9
  v_mfma_f32_16x16x32_bf16 v[40:43], v[16:19], v[92:95], 0
  v_exp_f32 v10, v126
  v_mfma_f32_16x16x32_bf16 v[40:43], v[20:23], v[92:95], v[40:43]
  v_exp_f32 v11, v127
  v_mfma_f32_16x16x32_bf16 v[44:47], v[24:27], v[92:95], 0
  v_add_f32 v12, v12, v10
  v_cvt_pk_bf16_f32 v55, v10, v11
  v_mfma_f32_16x16x32_bf16 v[44:47], v[28:31], v[92:95], v[44:47]
  v_add_f32 v12, v12, v11
  v_mfma_f32_16x16x32_bf16 v[120:123], v[192:195], a[32:35], 0
  v_exp_f32 v8, v112
  v_mfma_f32_16x16x32_bf16 v[120:123], v[196:199], a[36:39], v[120:123]
  v_cvt_pk_bf16_f32 v32, v32, v33
  v_cvt_pk_bf16_f32 v34, v34, v35
  v_mfma_f32_16x16x32_bf16 v[120:123], v[200:203], a[40:43], v[120:123]
  v_cvt_pk_bf16_f32 v36, v36, v37
  v_cvt_pk_bf16_f32 v38, v38, v39
  v_mfma_f32_16x16x32_bf16 v[120:123], v[204:207], a[44:47], v[120:123]
  v_accvgpr_write_b32 a72, v32
  v_accvgpr_write_b32 a73, v34
  v_mfma_f32_16x16x32_bf16 v[120:123], v[208:211], a[48:51], v[120:123]
  v_accvgpr_write_b32 a74, v36
  v_accvgpr_write_b32 a75, v38
  v_mfma_f32_16x16x32_bf16 v[120:123], v[212:215], a[52:55], v[120:123]
  v_cvt_pk_bf16_f32 v40, v40, v41
  v_cvt_pk_bf16_f32 v42, v42, v43
  v_mfma_f32_16x16x32_bf16 v[120:123], v[216:219], a[56:59], v[120:123]
  v_cvt_pk_bf16_f32 v44, v44, v45
  v_cvt_pk_bf16_f32 v46, v46, v47
  v_mfma_f32_16x16x32_bf16 v[120:123], v[220:223], a[60:63], v[120:123]
  v_accvgpr_write_b32 a76, v40
  s_waitcnt lgkmcnt(0)
  v_mfma_f32_16x16x32_bf16 v[32:35], v[16:19], v[96:99], 0
  v_accvgpr_write_b32 a77, v42
  v_accvgpr_write_b32 a78, v44
  v_mfma_f32_16x16x32_bf16 v[32:35], v[20:23], v[96:99], v[32:35]
  v_accvgpr_write_b32 a79, v46
  v_mfma_f32_16x16x32_bf16 v[36:39], v[24:27], v[96:99], 0
  v_exp_f32 v9, v113
  v_mfma_f32_16x16x32_bf16 v[36:39], v[28:31], v[96:99], v[36:39]
  v_add_f32 v13, v13, v8
  v_cvt_pk_bf16_f32 v56, v8, v9
  v_mfma_f32_16x16x32_bf16 v[40:43], v[16:19], v[100:103], 0
  v_add_f32 v13, v13, v9
  v_mfma_f32_16x16x32_bf16 v[40:43], v[20:23], v[100:103], v[40:43]
  v_exp_f32 v10, v114
  v_mfma_f32_16x16x32_bf16 v[44:47], v[24:27], v[100:103], 0
  v_exp_f32 v11, v115
  v_mfma_f32_16x16x32_bf16 v[44:47], v[28:31], v[100:103], v[44:47]
  v_add_f32 v13, v13, v10
  v_cvt_pk_bf16_f32 v57, v10, v11
  v_mfma_f32_16x16x32_bf16 v[124:127], v[224:227], a[32:35], 0
  v_add_f32 v13, v13, v11
  v_mfma_f32_16x16x32_bf16 v[124:127], v[228:231], a[36:39], v[124:127]
  v_cvt_pk_bf16_f32 v32, v32, v33
  v_cvt_pk_bf16_f32 v34, v34, v35
  v_mfma_f32_16x16x32_bf16 v[124:127], v[232:235], a[40:43], v[124:127]
  v_cvt_pk_bf16_f32 v36, v36, v37
  v_cvt_pk_bf16_f32 v38, v38, v39
  v_mfma_f32_16x16x32_bf16 v[124:127], v[236:239], a[44:47], v[124:127]
  v_accvgpr_write_b32 a80, v32
  v_accvgpr_write_b32 a81, v34
  v_mfma_f32_16x16x32_bf16 v[124:127], v[240:243], a[48:51], v[124:127]
  v_accvgpr_write_b32 a82, v36
  v_accvgpr_write_b32 a83, v38
  v_mfma_f32_16x16x32_bf16 v[124:127], v[244:247], a[52:55], v[124:127]
  v_cvt_pk_bf16_f32 v40, v40, v41
  v_cvt_pk_bf16_f32 v42, v42, v43
  v_mfma_f32_16x16x32_bf16 v[124:127], v[248:251], a[56:59], v[124:127]
  v_cvt_pk_bf16_f32 v44, v44, v45
  v_cvt_pk_bf16_f32 v46, v46, v47
  v_mfma_f32_16x16x32_bf16 v[124:127], v[252:255], a[60:63], v[124:127]
  v_accvgpr_write_b32 a84, v40
  v_accvgpr_write_b32 a85, v42
  v_mfma_f32_16x16x32_bf16 v[32:35], v[16:19], v[104:107], 0
  v_accvgpr_write_b32 a86, v44
  v_accvgpr_write_b32 a87, v46
  v_mfma_f32_16x16x32_bf16 v[32:35], v[20:23], v[104:107], v[32:35]
  v_exp_f32 v8, v116
  v_mfma_f32_16x16x32_bf16 v[36:39], v[24:27], v[104:107], 0
  v_exp_f32 v9, v117
  v_mfma_f32_16x16x32_bf16 v[36:39], v[28:31], v[104:107], v[36:39]
  v_add_f32 v13, v13, v8
  v_cvt_pk_bf16_f32 v58, v8, v9
  v_mfma_f32_16x16x32_bf16 v[40:43], v[16:19], v[108:111], 0
  v_add_f32 v13, v13, v9
  v_mfma_f32_16x16x32_bf16 v[40:43], v[20:23], v[108:111], v[40:43]
  v_exp_f32 v10, v118
  v_mfma_f32_16x16x32_bf16 v[44:47], v[24:27], v[108:111], 0
  v_exp_f32 v11, v119
  v_mfma_f32_16x16x32_bf16 v[44:47], v[28:31], v[108:111], v[44:47]
  v_add_f32 v13, v13, v10
  v_cvt_pk_bf16_f32 v59, v10, v11
  s_waitcnt vmcnt(4)
  s_barrier
  ds_read_b128 v[80:83], v7 offset:57344
  ds_read_b128 v[84:87], v7 offset:57856
  ds_read_b128 v[88:91], v7 offset:59392
  ds_read_b128 v[92:95], v7 offset:59904
  ds_read_b128 v[96:99], v7 offset:61440
  ds_read_b128 v[100:103], v7 offset:61952
  ds_read_b128 v[104:107], v7 offset:63488
  ds_read_b128 v[108:111], v7 offset:64000
  v_mfma_f32_16x16x32_bf16 v[112:115], v[128:131], a[64:67], 0
  v_add_f32 v13, v13, v11
  v_mfma_f32_16x16x32_bf16 v[112:115], v[132:135], a[68:71], v[112:115]
  v_cvt_pk_bf16_f32 v32, v32, v33
  v_cvt_pk_bf16_f32 v34, v34, v35
  v_mfma_f32_16x16x32_bf16 v[112:115], v[136:139], a[72:75], v[112:115]
  v_cvt_pk_bf16_f32 v36, v36, v37
  v_cvt_pk_bf16_f32 v38, v38, v39
  v_mfma_f32_16x16x32_bf16 v[112:115], v[140:143], a[76:79], v[112:115]
  v_accvgpr_write_b32 a88, v32
  v_accvgpr_write_b32 a89, v34
  v_mfma_f32_16x16x32_bf16 v[112:115], v[144:147], a[80:83], v[112:115]
  v_accvgpr_write_b32 a90, v36
  v_accvgpr_write_b32 a91, v38
  v_mfma_f32_16x16x32_bf16 v[112:115], v[148:151], a[84:87], v[112:115]
  s_add_u32 m0, s25, 0
  v_cvt_pk_bf16_f32 v40, v40, v41
  v_cvt_pk_bf16_f32 v42, v42, v43
  v_cvt_pk_bf16_f32 v44, v44, v45
  v_cvt_pk_bf16_f32 v46, v46, v47
  v_accvgpr_write_b32 a92, v40
  v_accvgpr_write_b32 a93, v42
  v_accvgpr_write_b32 a94, v44
  v_accvgpr_write_b32 a95, v46
  v_mfma_f32_16x16x32_bf16 v[112:115], v[152:155], a[88:91], v[112:115]
  buffer_load_dwordx4 v4, s[8:11], s32 offen offset:0 lds
  s_nop 1
  v_mfma_f32_16x16x32_bf16 v[112:115], v[156:159], a[92:95], v[112:115]
  buffer_load_dwordx4 v4, s[8:11], s33 offen offset:1024 lds
  s_waitcnt lgkmcnt(4)
  v_mfma_f32_16x16x32_bf16 v[32:35], v[16:19], v[80:83], 0
  buffer_load_dwordx4 v4, s[8:11], s34 offen offset:2048 lds
  v_mfma_f32_16x16x32_bf16 v[32:35], v[20:23], v[80:83], v[32:35]
  buffer_load_dwordx4 v4, s[8:11], s35 offen offset:3072 lds
  v_mfma_f32_16x16x32_bf16 v[36:39], v[24:27], v[80:83], 0
  v_exp_f32 v8, v120
  v_mfma_f32_16x16x32_bf16 v[36:39], v[28:31], v[80:83], v[36:39]
  v_exp_f32 v9, v121
  v_mfma_f32_16x16x32_bf16 v[40:43], v[16:19], v[84:87], 0
  s_add_u32 m0, s25, 24576
  v_add_f32 v13, v13, v8
  v_mfma_f32_16x16x32_bf16 v[40:43], v[20:23], v[84:87], v[40:43]
  buffer_load_dwordx4 v5, s[12:15], s52 offen offset:0 lds
  v_cvt_pk_bf16_f32 v60, v8, v9
  v_mfma_f32_16x16x32_bf16 v[44:47], v[24:27], v[84:87], 0
  v_add_f32 v13, v13, v9
  v_mfma_f32_16x16x32_bf16 v[44:47], v[28:31], v[84:87], v[44:47]
  buffer_load_dwordx4 v5, s[12:15], s53 offen offset:1024 lds
  v_mfma_f32_16x16x32_bf16 v[116:119], v[160:163], a[64:67], 0
  v_exp_f32 v10, v122
  v_mfma_f32_16x16x32_bf16 v[116:119], v[164:167], a[68:71], v[116:119]
  buffer_load_dwordx4 v5, s[12:15], s54 offen offset:2048 lds
  v_cvt_pk_bf16_f32 v32, v32, v33
  v_mfma_f32_16x16x32_bf16 v[116:119], v[168:171], a[72:75], v[116:119]
  v_cvt_pk_bf16_f32 v34, v34, v35
  v_cvt_pk_bf16_f32 v36, v36, v37
  v_mfma_f32_16x16x32_bf16 v[116:119], v[172:175], a[76:79], v[116:119]
  buffer_load_dwordx4 v5, s[12:15], s55 offen offset:3072 lds
  v_cvt_pk_bf16_f32 v38, v38, v39
  v_mfma_f32_16x16x32_bf16 v[116:119], v[176:179], a[80:83], v[116:119]
  v_accvgpr_write_b32 a96, v32
  v_accvgpr_write_b32 a97, v34
  v_mfma_f32_16x16x32_bf16 v[116:119], v[180:183], a[84:87], v[116:119]
  v_accvgpr_write_b32 a98, v36
  v_accvgpr_write_b32 a99, v38
  v_mfma_f32_16x16x32_bf16 v[116:119], v[184:187], a[88:91], v[116:119]
  s_add_u32 m0, s25, 16384
  v_cvt_pk_bf16_f32 v40, v40, v41
  v_mfma_f32_16x16x32_bf16 v[116:119], v[188:191], a[92:95], v[116:119]
  buffer_load_dwordx4 v4, s[8:11], s36 offen offset:0 lds
  v_cvt_pk_bf16_f32 v42, v42, v43
  v_mfma_f32_16x16x32_bf16 v[32:35], v[16:19], v[88:91], 0
  v_cvt_pk_bf16_f32 v44, v44, v45
  v_cvt_pk_bf16_f32 v46, v46, v47
  v_mfma_f32_16x16x32_bf16 v[32:35], v[20:23], v[88:91], v[32:35]
  v_accvgpr_write_b32 a100, v40
  v_accvgpr_write_b32 a101, v42
  v_mfma_f32_16x16x32_bf16 v[36:39], v[24:27], v[88:91], 0
  v_accvgpr_write_b32 a102, v44
  v_accvgpr_write_b32 a103, v46
  v_mfma_f32_16x16x32_bf16 v[36:39], v[28:31], v[88:91], v[36:39]
  buffer_load_dwordx4 v4, s[8:11], s37 offen offset:1024 lds
  buffer_load_dwordx4 v4, s[8:11], s38 offen offset:2048 lds
  v_mfma_f32_16x16x32_bf16 v[40:43], v[16:19], v[92:95], 0
  v_exp_f32 v11, v123
  v_mfma_f32_16x16x32_bf16 v[40:43], v[20:23], v[92:95], v[40:43]
  buffer_load_dwordx4 v4, s[8:11], s39 offen offset:3072 lds
  v_add_f32 v13, v13, v10
  v_mfma_f32_16x16x32_bf16 v[44:47], v[24:27], v[92:95], 0
  v_cvt_pk_bf16_f32 v61, v10, v11
  v_add_f32 v13, v13, v11
  v_mfma_f32_16x16x32_bf16 v[44:47], v[28:31], v[92:95], v[44:47]
  v_exp_f32 v8, v124
  v_mfma_f32_16x16x32_bf16 v[120:123], v[192:195], a[64:67], 0
  v_exp_f32 v9, v125
  v_mfma_f32_16x16x32_bf16 v[120:123], v[196:199], a[68:71], v[120:123]
  v_cvt_pk_bf16_f32 v32, v32, v33
  v_cvt_pk_bf16_f32 v34, v34, v35
  v_mfma_f32_16x16x32_bf16 v[120:123], v[200:203], a[72:75], v[120:123]
  v_cvt_pk_bf16_f32 v36, v36, v37
  v_cvt_pk_bf16_f32 v38, v38, v39
  v_mfma_f32_16x16x32_bf16 v[120:123], v[204:207], a[76:79], v[120:123]
  v_accvgpr_write_b32 a104, v32
  v_accvgpr_write_b32 a105, v34
  v_mfma_f32_16x16x32_bf16 v[120:123], v[208:211], a[80:83], v[120:123]
  v_accvgpr_write_b32 a106, v36
  v_accvgpr_write_b32 a107, v38
  v_mfma_f32_16x16x32_bf16 v[120:123], v[212:215], a[84:87], v[120:123]
  v_cvt_pk_bf16_f32 v40, v40, v41
  v_cvt_pk_bf16_f32 v42, v42, v43
  v_mfma_f32_16x16x32_bf16 v[120:123], v[216:219], a[88:91], v[120:123]
  v_cvt_pk_bf16_f32 v44, v44, v45
  v_cvt_pk_bf16_f32 v46, v46, v47
  v_mfma_f32_16x16x32_bf16 v[120:123], v[220:223], a[92:95], v[120:123]
  v_accvgpr_write_b32 a108, v40
  s_waitcnt lgkmcnt(0)
  v_mfma_f32_16x16x32_bf16 v[32:35], v[16:19], v[96:99], 0
  v_accvgpr_write_b32 a109, v42
  v_accvgpr_write_b32 a110, v44
  v_mfma_f32_16x16x32_bf16 v[32:35], v[20:23], v[96:99], v[32:35]
  v_accvgpr_write_b32 a111, v46
  v_add_f32 v13, v13, v8
  v_mfma_f32_16x16x32_bf16 v[36:39], v[24:27], v[96:99], 0
  v_cvt_pk_bf16_f32 v62, v8, v9
  v_add_f32 v13, v13, v9
  v_mfma_f32_16x16x32_bf16 v[36:39], v[28:31], v[96:99], v[36:39]
  v_exp_f32 v10, v126
  v_mfma_f32_16x16x32_bf16 v[40:43], v[16:19], v[100:103], 0
  v_exp_f32 v11, v127
  v_mfma_f32_16x16x32_bf16 v[40:43], v[20:23], v[100:103], v[40:43]
  v_add_f32 v13, v13, v10
  v_cvt_pk_bf16_f32 v63, v10, v11
  v_mfma_f32_16x16x32_bf16 v[44:47], v[24:27], v[100:103], 0
  v_add_f32 v13, v13, v11
  v_mfma_f32_16x16x32_bf16 v[44:47], v[28:31], v[100:103], v[44:47]
  v_exp_f32 v8, v112
  v_mfma_f32_16x16x32_bf16 v[124:127], v[224:227], a[64:67], 0
  v_exp_f32 v9, v113
  v_mfma_f32_16x16x32_bf16 v[124:127], v[228:231], a[68:71], v[124:127]
  v_cvt_pk_bf16_f32 v32, v32, v33
  v_cvt_pk_bf16_f32 v34, v34, v35
  v_mfma_f32_16x16x32_bf16 v[124:127], v[232:235], a[72:75], v[124:127]
  v_cvt_pk_bf16_f32 v36, v36, v37
  v_cvt_pk_bf16_f32 v38, v38, v39
  v_mfma_f32_16x16x32_bf16 v[124:127], v[236:239], a[76:79], v[124:127]
  v_accvgpr_write_b32 a112, v32
  v_accvgpr_write_b32 a113, v34
  v_mfma_f32_16x16x32_bf16 v[124:127], v[240:243], a[80:83], v[124:127]
  v_accvgpr_write_b32 a114, v36
  v_accvgpr_write_b32 a115, v38
  v_mfma_f32_16x16x32_bf16 v[124:127], v[244:247], a[84:87], v[124:127]
  v_cvt_pk_bf16_f32 v40, v40, v41
  v_cvt_pk_bf16_f32 v42, v42, v43
  v_mfma_f32_16x16x32_bf16 v[124:127], v[248:251], a[88:91], v[124:127]
  v_cvt_pk_bf16_f32 v44, v44, v45
  v_cvt_pk_bf16_f32 v46, v46, v47
  v_mfma_f32_16x16x32_bf16 v[124:127], v[252:255], a[92:95], v[124:127]
  v_accvgpr_write_b32 a116, v40
  v_accvgpr_write_b32 a117, v42
  v_mfma_f32_16x16x32_bf16 v[32:35], v[16:19], v[104:107], 0
  v_accvgpr_write_b32 a118, v44
  v_accvgpr_write_b32 a119, v46
  v_mfma_f32_16x16x32_bf16 v[32:35], v[20:23], v[104:107], v[32:35]
  v_add_f32 v14, v14, v8
  v_cvt_pk_bf16_f32 v64, v8, v9
  v_mfma_f32_16x16x32_bf16 v[36:39], v[24:27], v[104:107], 0
  v_add_f32 v14, v14, v9
  v_mfma_f32_16x16x32_bf16 v[36:39], v[28:31], v[104:107], v[36:39]
  v_exp_f32 v10, v114
  v_mfma_f32_16x16x32_bf16 v[40:43], v[16:19], v[108:111], 0
  v_exp_f32 v11, v115
  v_mfma_f32_16x16x32_bf16 v[40:43], v[20:23], v[108:111], v[40:43]
  v_add_f32 v14, v14, v10
  v_cvt_pk_bf16_f32 v65, v10, v11
  v_mfma_f32_16x16x32_bf16 v[44:47], v[24:27], v[108:111], 0
  v_add_f32 v14, v14, v11
  v_mfma_f32_16x16x32_bf16 v[44:47], v[28:31], v[108:111], v[44:47]
  v_exp_f32 v8, v116
  s_waitcnt vmcnt(8)
  s_barrier
  v_mfma_f32_16x16x32_bf16 v[112:115], v[128:131], a[96:99], 0
  v_exp_f32 v9, v117
  v_mfma_f32_16x16x32_bf16 v[112:115], v[132:135], a[100:103], v[112:115]
  v_cvt_pk_bf16_f32 v32, v32, v33
  v_cvt_pk_bf16_f32 v34, v34, v35
  v_mfma_f32_16x16x32_bf16 v[112:115], v[136:139], a[104:107], v[112:115]
  v_cvt_pk_bf16_f32 v36, v36, v37
  v_cvt_pk_bf16_f32 v38, v38, v39
  v_mfma_f32_16x16x32_bf16 v[112:115], v[140:143], a[108:111], v[112:115]
  v_accvgpr_write_b32 a120, v32
  v_accvgpr_write_b32 a121, v34
  v_mfma_f32_16x16x32_bf16 v[112:115], v[144:147], a[112:115], v[112:115]
  v_accvgpr_write_b32 a122, v36
  v_accvgpr_write_b32 a123, v38
  v_mfma_f32_16x16x32_bf16 v[112:115], v[148:151], a[116:119], v[112:115]
  s_add_u32 m0, s25, 40960
  v_cvt_pk_bf16_f32 v40, v40, v41
  v_cvt_pk_bf16_f32 v42, v42, v43
  v_cvt_pk_bf16_f32 v44, v44, v45
  v_cvt_pk_bf16_f32 v46, v46, v47
  v_accvgpr_write_b32 a124, v40
  v_accvgpr_write_b32 a125, v42
  v_accvgpr_write_b32 a126, v44
  v_accvgpr_write_b32 a127, v46
  v_mfma_f32_16x16x32_bf16 v[112:115], v[152:155], a[120:123], v[112:115]
  buffer_load_dwordx4 v5, s[12:15], s56 offen offset:0 lds
  s_nop 1
  v_mfma_f32_16x16x32_bf16 v[112:115], v[156:159], a[124:127], v[112:115]
  v_add_f32 v14, v14, v8
  v_cvt_pk_bf16_f32 v66, v8, v9
  v_add_f32 v14, v14, v9
  v_exp_f32 v10, v118
  v_exp_f32 v11, v119
  v_mfma_f32_16x16x32_bf16 v[116:119], v[160:163], a[96:99], 0
  buffer_load_dwordx4 v5, s[12:15], s57 offen offset:1024 lds
  buffer_load_dwordx4 v5, s[12:15], s58 offen offset:2048 lds
  v_mfma_f32_16x16x32_bf16 v[116:119], v[164:167], a[100:103], v[116:119]
  v_add_f32 v14, v14, v10
  v_cvt_pk_bf16_f32 v67, v10, v11
  v_mfma_f32_16x16x32_bf16 v[116:119], v[168:171], a[104:107], v[116:119]
  v_add_f32 v14, v14, v11
  buffer_load_dwordx4 v5, s[12:15], s59 offen offset:3072 lds
  v_mfma_f32_16x16x32_bf16 v[116:119], v[172:175], a[108:111], v[116:119]
  v_exp_f32 v8, v120
  v_mfma_f32_16x16x32_bf16 v[116:119], v[176:179], a[112:115], v[116:119]
  s_add_u32 m0, s25, 32768
  v_mfma_f32_16x16x32_bf16 v[116:119], v[180:183], a[116:119], v[116:119]
  v_exp_f32 v9, v121
  v_mfma_f32_16x16x32_bf16 v[116:119], v[184:187], a[120:123], v[116:119]
  v_add_f32 v14, v14, v8
  v_cvt_pk_bf16_f32 v68, v8, v9
  v_mfma_f32_16x16x32_bf16 v[116:119], v[188:191], a[124:127], v[116:119]
  v_add_f32 v14, v14, v9
  v_exp_f32 v10, v122
  v_exp_f32 v11, v123
  v_and_b32 v88, 63, v0
  v_lshlrev_b32 v7, 7, v88
  s_lshl_b32 s76, s23, 20
  s_lshl_b32 s77, s22, 19
  s_add_u32 s76, s76, s77
  s_lshl_b32 s77, s24, 11
  s_add_u32 s76, s76, s77
  s_add_u32 s76, s76, 65536
  v_add_u32 v7, s76, v7
  v_cmp_gt_u32 vcc, 16, v88
  v_mov_b32 v88, 0x40000000
  s_nop 0
  v_cndmask_b32 v7, v88, v7, vcc
  v_mfma_f32_16x16x32_bf16 v[120:123], v[192:195], a[96:99], 0
  buffer_load_dwordx4 v4, s[8:11], s40 offen offset:0 lds
  buffer_load_dwordx4 v4, s[8:11], s41 offen offset:1024 lds
  v_mfma_f32_16x16x32_bf16 v[120:123], v[196:199], a[100:103], v[120:123]
  v_add_f32 v14, v14, v10
  v_cvt_pk_bf16_f32 v69, v10, v11
  v_mfma_f32_16x16x32_bf16 v[120:123], v[200:203], a[104:107], v[120:123]
  v_add_f32 v14, v14, v11
  buffer_load_dwordx4 v4, s[8:11], s42 offen offset:2048 lds
  v_mfma_f32_16x16x32_bf16 v[120:123], v[204:207], a[108:111], v[120:123]
  buffer_load_dwordx4 v4, s[8:11], s43 offen offset:3072 lds
  v_mfma_f32_16x16x32_bf16 v[120:123], v[208:211], a[112:115], v[120:123]
  v_exp_f32 v8, v124
  v_mfma_f32_16x16x32_bf16 v[120:123], v[212:215], a[116:119], v[120:123]
  v_exp_f32 v9, v125
  v_mfma_f32_16x16x32_bf16 v[120:123], v[216:219], a[120:123], v[120:123]
  v_add_f32 v14, v14, v8
  v_cvt_pk_bf16_f32 v70, v8, v9
  v_mfma_f32_16x16x32_bf16 v[120:123], v[220:223], a[124:127], v[120:123]
  v_add_f32 v14, v14, v9
  v_exp_f32 v10, v126
  v_exp_f32 v11, v127
  v_mfma_f32_16x16x32_bf16 v[124:127], v[224:227], a[96:99], 0
  ds_read_b128 v[16:19], v1 offset:0
  ds_read_b128 v[20:23], v1 offset:512
  v_mfma_f32_16x16x32_bf16 v[124:127], v[228:231], a[100:103], v[124:127]
  ds_read_b128 v[24:27], v1 offset:2048
  v_add_f32 v14, v14, v10
  v_mfma_f32_16x16x32_bf16 v[124:127], v[232:235], a[104:107], v[124:127]
  v_cvt_pk_bf16_f32 v71, v10, v11
  v_add_f32 v14, v14, v11
  v_mfma_f32_16x16x32_bf16 v[124:127], v[236:239], a[108:111], v[124:127]
  ds_read_b128 v[28:31], v1 offset:2560
  ds_read_b128 v[32:35], v1 offset:4096
  v_mfma_f32_16x16x32_bf16 v[124:127], v[240:243], a[112:115], v[124:127]
  ds_read_b128 v[36:39], v1 offset:4608
  ds_read_b128 v[40:43], v1 offset:6144
  v_mfma_f32_16x16x32_bf16 v[124:127], v[244:247], a[116:119], v[124:127]
  v_exp_f32 v8, v112
  v_mfma_f32_16x16x32_bf16 v[124:127], v[248:251], a[120:123], v[124:127]
  v_exp_f32 v9, v113
  v_mfma_f32_16x16x32_bf16 v[124:127], v[252:255], a[124:127], v[124:127]
  v_add_f32 v15, v15, v8
  v_cvt_pk_bf16_f32 v72, v8, v9
  v_add_f32 v15, v15, v9
  v_exp_f32 v10, v114
  v_exp_f32 v11, v115
  s_waitcnt vmcnt(8) lgkmcnt(5)
  s_barrier
  v_mfma_f32_16x16x32_bf16 v[112:115], v[16:19], a[0:3], 0
  ds_read_b128 v[44:47], v1 offset:6656
  v_add_f32 v15, v15, v10
  v_mfma_f32_16x16x32_bf16 v[112:115], v[20:23], a[4:7], v[112:115]
  v_cvt_pk_bf16_f32 v73, v10, v11
  s_waitcnt lgkmcnt(4)
  v_mfma_f32_16x16x32_bf16 v[112:115], v[24:27], a[8:11], v[112:115]
  v_add_f32 v15, v15, v11
  s_add_u32 m0, s25, 49152
  v_mfma_f32_16x16x32_bf16 v[112:115], v[28:31], a[12:15], v[112:115]
  buffer_load_dwordx4 v4, s[8:11], s44 offen offset:0 lds
  s_waitcnt lgkmcnt(2)
  v_mfma_f32_16x16x32_bf16 v[112:115], v[32:35], a[16:19], v[112:115]
  v_exp_f32 v8, v116
  v_mfma_f32_16x16x32_bf16 v[112:115], v[36:39], a[20:23], v[112:115]
  s_waitcnt lgkmcnt(0)
  v_mfma_f32_16x16x32_bf16 v[112:115], v[40:43], a[24:27], v[112:115]
  v_exp_f32 v9, v117
  v_mfma_f32_16x16x32_bf16 v[112:115], v[44:47], a[28:31], v[112:115]
  v_add_f32 v15, v15, v8
  v_cvt_pk_bf16_f32 v74, v8, v9
  v_add_f32 v15, v15, v9
  v_exp_f32 v10, v118
  v_exp_f32 v11, v119
  v_mfma_f32_16x16x32_bf16 v[116:119], v[16:19], a[32:35], 0
  v_add_f32 v15, v15, v10
  v_cvt_pk_bf16_f32 v75, v10, v11
  v_mfma_f32_16x16x32_bf16 v[116:119], v[20:23], a[36:39], v[116:119]
  v_add_f32 v15, v15, v11
  buffer_load_dwordx4 v4, s[8:11], s45 offen offset:1024 lds
  v_mfma_f32_16x16x32_bf16 v[116:119], v[24:27], a[40:43], v[116:119]
  v_exp_f32 v8, v120
  v_mfma_f32_16x16x32_bf16 v[116:119], v[28:31], a[44:47], v[116:119]
  v_exp_f32 v9, v121
  v_mfma_f32_16x16x32_bf16 v[116:119], v[32:35], a[48:51], v[116:119]
  v_add_f32 v15, v15, v8
  v_cvt_pk_bf16_f32 v76, v8, v9
  v_mfma_f32_16x16x32_bf16 v[116:119], v[36:39], a[52:55], v[116:119]
  v_add_f32 v15, v15, v9
  buffer_load_dwordx4 v4, s[8:11], s46 offen offset:2048 lds
  v_mfma_f32_16x16x32_bf16 v[116:119], v[40:43], a[56:59], v[116:119]
  v_exp_f32 v10, v122
  v_mfma_f32_16x16x32_bf16 v[116:119], v[44:47], a[60:63], v[116:119]
  v_exp_f32 v11, v123
  v_mfma_f32_16x16x32_bf16 v[120:123], v[16:19], a[64:67], 0
  v_add_f32 v15, v15, v10
  v_cvt_pk_bf16_f32 v77, v10, v11
  v_mfma_f32_16x16x32_bf16 v[120:123], v[20:23], a[68:71], v[120:123]
  v_add_f32 v15, v15, v11
  v_mfma_f32_16x16x32_bf16 v[120:123], v[24:27], a[72:75], v[120:123]
  v_exp_f32 v8, v124
  v_mfma_f32_16x16x32_bf16 v[120:123], v[28:31], a[76:79], v[120:123]
  v_exp_f32 v9, v125
  v_mfma_f32_16x16x32_bf16 v[120:123], v[32:35], a[80:83], v[120:123]
  v_add_f32 v15, v15, v8
  v_cvt_pk_bf16_f32 v78, v8, v9
  v_mfma_f32_16x16x32_bf16 v[120:123], v[36:39], a[84:87], v[120:123]
  v_add_f32 v15, v15, v9
  buffer_load_dwordx4 v4, s[8:11], s47 offen offset:3072 lds
  v_mfma_f32_16x16x32_bf16 v[120:123], v[40:43], a[88:91], v[120:123]
  v_exp_f32 v10, v126
  v_mfma_f32_16x16x32_bf16 v[120:123], v[44:47], a[92:95], v[120:123]
  v_exp_f32 v11, v127
  v_mfma_f32_16x16x32_bf16 v[124:127], v[16:19], a[96:99], 0
  ds_read_b64_tr_b16 v[16:17], v2 offset:8192
  ds_read_b64_tr_b16 v[18:19], v2 offset:10240
  v_mfma_f32_16x16x32_bf16 v[124:127], v[20:23], a[100:103], v[124:127]
  ds_read_b64_tr_b16 v[20:21], v2 offset:12288
  ds_read_b64_tr_b16 v[22:23], v2 offset:14336
  v_mfma_f32_16x16x32_bf16 v[124:127], v[24:27], a[104:107], v[124:127]
  v_add_f32 v15, v15, v10
  v_cvt_pk_bf16_f32 v79, v10, v11
  v_mfma_f32_16x16x32_bf16 v[124:127], v[28:31], a[108:111], v[124:127]
  v_add_f32 v15, v15, v11
  v_add_u32 v4, 0x8000, v4
  v_mfma_f32_16x16x32_bf16 v[124:127], v[32:35], a[112:115], v[124:127]
  v_exp_f32 v8, v112
  v_mfma_f32_16x16x32_bf16 v[124:127], v[36:39], a[116:119], v[124:127]
  v_exp_f32 v9, v113
  v_mfma_f32_16x16x32_bf16 v[124:127], v[40:43], a[120:123], v[124:127]
  ds_read_b64_tr_b16 v[24:25], v3 offset:8192
  ds_read_b64_tr_b16 v[26:27], v3 offset:10240
  v_mfma_f32_16x16x32_bf16 v[124:127], v[44:47], a[124:127], v[124:127]
  ds_read_b64_tr_b16 v[28:29], v3 offset:12288
  s_waitcnt lgkmcnt(3)
  v_mfma_f32_16x16x32_bf16 a[128:131], v[16:19], v[48:51], 0
  ds_read_b64_tr_b16 v[30:31], v3 offset:14336
  s_add_u32 m0, s25, 57344
  v_mfma_f32_16x16x32_bf16 a[128:131], v[20:23], v[52:55], a[128:131]
  buffer_load_dwordx4 v5, s[12:15], s60 offen offset:0 lds
  v_add_f32 v12, v12, v8
  v_mfma_f32_16x16x32_bf16 a[132:135], v[16:19], v[56:59], 0
  v_cvt_pk_bf16_f32 v80, v8, v9
  v_add_f32 v12, v12, v9
  v_mfma_f32_16x16x32_bf16 a[132:135], v[20:23], v[60:63], a[132:135]
  v_exp_f32 v10, v114
  v_mfma_f32_16x16x32_bf16 a[136:139], v[16:19], v[64:67], 0
  v_exp_f32 v11, v115
  v_mfma_f32_16x16x32_bf16 a[136:139], v[20:23], v[68:71], a[136:139]
  v_add_f32 v12, v12, v10
  v_cvt_pk_bf16_f32 v81, v10, v11
  v_mfma_f32_16x16x32_bf16 a[140:143], v[16:19], v[72:75], 0
  ds_read_b64_tr_b16 v[32:33], v2 offset:8704
  ds_read_b64_tr_b16 v[34:35], v2 offset:10752
  v_mfma_f32_16x16x32_bf16 a[140:143], v[20:23], v[76:79], a[140:143]
  ds_read_b64_tr_b16 v[36:37], v2 offset:12800
  s_waitcnt lgkmcnt(3)
  v_mfma_f32_16x16x32_bf16 a[144:147], v[24:27], v[48:51], 0
  ds_read_b64_tr_b16 v[38:39], v2 offset:14848
  buffer_load_dwordx4 v5, s[12:15], s61 offen offset:1024 lds
  v_mfma_f32_16x16x32_bf16 a[144:147], v[28:31], v[52:55], a[144:147]
  v_add_f32 v12, v12, v11
  v_mfma_f32_16x16x32_bf16 a[148:151], v[24:27], v[56:59], 0
  v_exp_f32 v8, v116
  v_mfma_f32_16x16x32_bf16 a[148:151], v[28:31], v[60:63], a[148:151]
  v_exp_f32 v9, v117
  v_mfma_f32_16x16x32_bf16 a[152:155], v[24:27], v[64:67], 0
  v_add_f32 v13, v13, v8
  v_cvt_pk_bf16_f32 v88, v8, v9
  v_mfma_f32_16x16x32_bf16 a[152:155], v[28:31], v[68:71], a[152:155]
  buffer_load_dwordx4 v5, s[12:15], s62 offen offset:2048 lds
  v_add_f32 v13, v13, v9
  v_mfma_f32_16x16x32_bf16 a[156:159], v[24:27], v[72:75], 0
  ds_read_b64_tr_b16 v[40:41], v3 offset:8704
  ds_read_b64_tr_b16 v[42:43], v3 offset:10752
  v_mfma_f32_16x16x32_bf16 a[156:159], v[28:31], v[76:79], a[156:159]
  ds_read_b64_tr_b16 v[44:45], v3 offset:12800
  s_waitcnt lgkmcnt(3)
  v_mfma_f32_16x16x32_bf16 a[160:163], v[32:35], v[48:51], 0
  ds_read_b64_tr_b16 v[46:47], v3 offset:14848
  v_mfma_f32_16x16x32_bf16 a[160:163], v[36:39], v[52:55], a[160:163]
  v_exp_f32 v10, v118
  v_mfma_f32_16x16x32_bf16 a[164:167], v[32:35], v[56:59], 0
  v_exp_f32 v11, v119
  v_mfma_f32_16x16x32_bf16 a[164:167], v[36:39], v[60:63], a[164:167]
  buffer_load_dwordx4 v5, s[12:15], s63 offen offset:3072 lds
  v_add_f32 v13, v13, v10
  v_mfma_f32_16x16x32_bf16 a[168:171], v[32:35], v[64:67], 0
  ds_read_b128 v[16:19], v1 offset:16384
  v_add_u32 v5, 0x8000, v5
  v_mfma_f32_16x16x32_bf16 a[168:171], v[36:39], v[68:71], a[168:171]
  ds_read_b128 v[20:23], v1 offset:16896
  v_cvt_pk_bf16_f32 v89, v10, v11
  v_mfma_f32_16x16x32_bf16 a[172:175], v[32:35], v[72:75], 0
  ds_read_b128 v[24:27], v1 offset:18432
  v_add_f32 v13, v13, v11
  v_mfma_f32_16x16x32_bf16 a[172:175], v[36:39], v[76:79], a[172:175]
  ds_read_b128 v[28:31], v1 offset:18944
  s_waitcnt lgkmcnt(4)
  v_mfma_f32_16x16x32_bf16 a[176:179], v[40:43], v[48:51], 0
  ds_read_b128 v[32:35], v1 offset:20480
  v_mfma_f32_16x16x32_bf16 a[176:179], v[44:47], v[52:55], a[176:179]
  ds_read_b128 v[36:39], v1 offset:20992
  v_mfma_f32_16x16x32_bf16 a[180:183], v[40:43], v[56:59], 0
  v_exp_f32 v8, v120
  v_mfma_f32_16x16x32_bf16 a[180:183], v[44:47], v[60:63], a[180:183]
  v_exp_f32 v9, v121
  v_mfma_f32_16x16x32_bf16 a[184:187], v[40:43], v[64:67], 0
  v_add_f32 v14, v14, v8
  v_cvt_pk_bf16_f32 v96, v8, v9
  v_mfma_f32_16x16x32_bf16 a[184:187], v[44:47], v[68:71], a[184:187]
  v_add_f32 v14, v14, v9
  v_mfma_f32_16x16x32_bf16 a[188:191], v[40:43], v[72:75], 0
  ds_read_b128 v[40:43], v1 offset:22528
  v_mfma_f32_16x16x32_bf16 a[188:191], v[44:47], v[76:79], a[188:191]
  s_waitcnt vmcnt(8) lgkmcnt(1)
  s_barrier
  v_mfma_f32_16x16x32_bf16 v[112:115], v[16:19], a[0:3], 0
  ds_read_b128 v[44:47], v1 offset:23040
  s_add_u32 m0, s25, 0
  v_mfma_f32_16x16x32_bf16 v[112:115], v[20:23], a[4:7], v[112:115]
  buffer_load_dwordx4 v4, s[8:11], s32 offen offset:0 lds
  v_mfma_f32_16x16x32_bf16 v[112:115], v[24:27], a[8:11], v[112:115]
  v_exp_f32 v10, v122
  v_mfma_f32_16x16x32_bf16 v[112:115], v[28:31], a[12:15], v[112:115]
  v_exp_f32 v11, v123
  v_mfma_f32_16x16x32_bf16 v[112:115], v[32:35], a[16:19], v[112:115]
  v_add_f32 v14, v14, v10
  v_cvt_pk_bf16_f32 v97, v10, v11
  v_mfma_f32_16x16x32_bf16 v[112:115], v[36:39], a[20:23], v[112:115]
  v_add_f32 v14, v14, v11
  s_waitcnt lgkmcnt(0)
  v_mfma_f32_16x16x32_bf16 v[112:115], v[40:43], a[24:27], v[112:115]
  v_exp_f32 v8, v124
  v_mfma_f32_16x16x32_bf16 v[112:115], v[44:47], a[28:31], v[112:115]
  buffer_load_dwordx4 v4, s[8:11], s33 offen offset:1024 lds
  v_mfma_f32_16x16x32_bf16 v[116:119], v[16:19], a[32:35], 0
  v_exp_f32 v9, v125
  v_mfma_f32_16x16x32_bf16 v[116:119], v[20:23], a[36:39], v[116:119]
  v_add_f32 v15, v15, v8
  v_cvt_pk_bf16_f32 v104, v8, v9
  v_mfma_f32_16x16x32_bf16 v[116:119], v[24:27], a[40:43], v[116:119]
  v_add_f32 v15, v15, v9
  v_mfma_f32_16x16x32_bf16 v[116:119], v[28:31], a[44:47], v[116:119]
  v_exp_f32 v10, v126
  v_mfma_f32_16x16x32_bf16 v[116:119], v[32:35], a[48:51], v[116:119]
  v_exp_f32 v11, v127
  v_mfma_f32_16x16x32_bf16 v[116:119], v[36:39], a[52:55], v[116:119]
  buffer_load_dwordx4 v4, s[8:11], s34 offen offset:2048 lds
  v_add_f32 v15, v15, v10
  v_mfma_f32_16x16x32_bf16 v[116:119], v[40:43], a[56:59], v[116:119]
  v_cvt_pk_bf16_f32 v105, v10, v11
  v_add_f32 v15, v15, v11
  v_mfma_f32_16x16x32_bf16 v[116:119], v[44:47], a[60:63], v[116:119]
  v_exp_f32 v8, v112
  v_mfma_f32_16x16x32_bf16 v[120:123], v[16:19], a[64:67], 0
  v_exp_f32 v9, v113
  v_mfma_f32_16x16x32_bf16 v[120:123], v[20:23], a[68:71], v[120:123]
  v_add_f32 v12, v12, v8
  v_cvt_pk_bf16_f32 v82, v8, v9
  v_mfma_f32_16x16x32_bf16 v[120:123], v[24:27], a[72:75], v[120:123]
  v_add_f32 v12, v12, v9
  v_mfma_f32_16x16x32_bf16 v[120:123], v[28:31], a[76:79], v[120:123]
  buffer_load_dwordx4 v4, s[8:11], s35 offen offset:3072 lds
  v_mfma_f32_16x16x32_bf16 v[120:123], v[32:35], a[80:83], v[120:123]
  v_exp_f32 v10, v114
  v_mfma_f32_16x16x32_bf16 v[120:123], v[36:39], a[84:87], v[120:123]
  v_exp_f32 v11, v115
  v_mfma_f32_16x16x32_bf16 v[120:123], v[40:43], a[88:91], v[120:123]
  v_add_f32 v12, v12, v10
  v_cvt_pk_bf16_f32 v83, v10, v11
  v_mfma_f32_16x16x32_bf16 v[120:123], v[44:47], a[92:95], v[120:123]
  v_add_f32 v12, v12, v11
  v_mfma_f32_16x16x32_bf16 v[124:127], v[16:19], a[96:99], 0
  ds_read_b64_tr_b16 v[16:17], v2 offset:24576
  ds_read_b64_tr_b16 v[18:19], v2 offset:26624
  v_mfma_f32_16x16x32_bf16 v[124:127], v[20:23], a[100:103], v[124:127]
  ds_read_b64_tr_b16 v[20:21], v2 offset:28672
  ds_read_b64_tr_b16 v[22:23], v2 offset:30720
  v_mfma_f32_16x16x32_bf16 v[124:127], v[24:27], a[104:107], v[124:127]
  v_mfma_f32_16x16x32_bf16 v[124:127], v[28:31], a[108:111], v[124:127]
  v_mfma_f32_16x16x32_bf16 v[124:127], v[32:35], a[112:115], v[124:127]
  v_mfma_f32_16x16x32_bf16 v[124:127], v[36:39], a[116:119], v[124:127]
  v_exp_f32 v8, v116
  v_mfma_f32_16x16x32_bf16 v[124:127], v[40:43], a[120:123], v[124:127]
  ds_read_b64_tr_b16 v[24:25], v3 offset:24576
  ds_read_b64_tr_b16 v[26:27], v3 offset:26624
  v_mfma_f32_16x16x32_bf16 v[124:127], v[44:47], a[124:127], v[124:127]
  ds_read_b64_tr_b16 v[28:29], v3 offset:28672
  s_waitcnt lgkmcnt(3)
  v_mfma_f32_16x16x32_bf16 a[192:195], v[16:19], v[48:51], 0
  ds_read_b64_tr_b16 v[30:31], v3 offset:30720
  s_add_u32 m0, s25, 8192
  v_mfma_f32_16x16x32_bf16 a[192:195], v[20:23], v[52:55], a[192:195]
  buffer_load_dwordx4 v5, s[12:15], s48 offen offset:0 lds
  v_mfma_f32_16x16x32_bf16 a[196:199], v[16:19], v[56:59], 0
  v_exp_f32 v9, v117
  v_mfma_f32_16x16x32_bf16 a[196:199], v[20:23], v[60:63], a[196:199]
  v_add_f32 v13, v13, v8
  v_cvt_pk_bf16_f32 v90, v8, v9
  v_mfma_f32_16x16x32_bf16 a[200:203], v[16:19], v[64:67], 0
  v_add_f32 v13, v13, v9
  v_mfma_f32_16x16x32_bf16 a[200:203], v[20:23], v[68:71], a[200:203]
  v_exp_f32 v10, v118
  v_mfma_f32_16x16x32_bf16 a[204:207], v[16:19], v[72:75], 0
  ds_read_b64_tr_b16 v[32:33], v2 offset:25088
  ds_read_b64_tr_b16 v[34:35], v2 offset:27136
  v_mfma_f32_16x16x32_bf16 a[204:207], v[20:23], v[76:79], a[204:207]
  ds_read_b64_tr_b16 v[36:37], v2 offset:29184
  s_waitcnt lgkmcnt(3)
  v_mfma_f32_16x16x32_bf16 a[208:211], v[24:27], v[48:51], 0
  ds_read_b64_tr_b16 v[38:39], v2 offset:31232
  buffer_load_dwordx4 v5, s[12:15], s49 offen offset:1024 lds
  v_mfma_f32_16x16x32_bf16 a[208:211], v[28:31], v[52:55], a[208:211]
  v_exp_f32 v11, v119
  v_mfma_f32_16x16x32_bf16 a[212:215], v[24:27], v[56:59], 0
  v_add_f32 v13, v13, v10
  v_cvt_pk_bf16_f32 v91, v10, v11
  v_mfma_f32_16x16x32_bf16 a[212:215], v[28:31], v[60:63], a[212:215]
  v_add_f32 v13, v13, v11
  v_mfma_f32_16x16x32_bf16 a[216:219], v[24:27], v[64:67], 0
  v_mfma_f32_16x16x32_bf16 a[216:219], v[28:31], v[68:71], a[216:219]
  buffer_load_dwordx4 v5, s[12:15], s50 offen offset:2048 lds
  v_mfma_f32_16x16x32_bf16 a[220:223], v[24:27], v[72:75], 0
  ds_read_b64_tr_b16 v[40:41], v3 offset:25088
  ds_read_b64_tr_b16 v[42:43], v3 offset:27136
  v_mfma_f32_16x16x32_bf16 a[220:223], v[28:31], v[76:79], a[220:223]
  ds_read_b64_tr_b16 v[44:45], v3 offset:29184
  s_waitcnt lgkmcnt(3)
  v_mfma_f32_16x16x32_bf16 a[224:227], v[32:35], v[48:51], 0
  ds_read_b64_tr_b16 v[46:47], v3 offset:31232
  v_mfma_f32_16x16x32_bf16 a[224:227], v[36:39], v[52:55], a[224:227]
  v_exp_f32 v8, v120
  v_mfma_f32_16x16x32_bf16 a[228:231], v[32:35], v[56:59], 0
  v_exp_f32 v9, v121
  v_mfma_f32_16x16x32_bf16 a[228:231], v[36:39], v[60:63], a[228:231]
  buffer_load_dwordx4 v5, s[12:15], s51 offen offset:3072 lds
  v_add_f32 v14, v14, v8
  v_mfma_f32_16x16x32_bf16 a[232:235], v[32:35], v[64:67], 0
  ds_read_b128 v[16:19], v1 offset:32768
  v_cvt_pk_bf16_f32 v98, v8, v9
  v_mfma_f32_16x16x32_bf16 a[232:235], v[36:39], v[68:71], a[232:235]
  ds_read_b128 v[20:23], v1 offset:33280
  v_add_f32 v14, v14, v9
  v_mfma_f32_16x16x32_bf16 a[236:239], v[32:35], v[72:75], 0
  ds_read_b128 v[24:27], v1 offset:34816
  v_mfma_f32_16x16x32_bf16 a[236:239], v[36:39], v[76:79], a[236:239]
  ds_read_b128 v[28:31], v1 offset:35328
  s_waitcnt lgkmcnt(4)
  v_mfma_f32_16x16x32_bf16 a[240:243], v[40:43], v[48:51], 0
  ds_read_b128 v[32:35], v1 offset:36864
  v_mfma_f32_16x16x32_bf16 a[240:243], v[44:47], v[52:55], a[240:243]
  ds_read_b128 v[36:39], v1 offset:37376
  v_mfma_f32_16x16x32_bf16 a[244:247], v[40:43], v[56:59], 0
  v_exp_f32 v10, v122
  v_mfma_f32_16x16x32_bf16 a[244:247], v[44:47], v[60:63], a[244:247]
  v_exp_f32 v11, v123
  v_mfma_f32_16x16x32_bf16 a[248:251], v[40:43], v[64:67], 0
  v_add_f32 v14, v14, v10
  v_cvt_pk_bf16_f32 v99, v10, v11
  v_mfma_f32_16x16x32_bf16 a[248:251], v[44:47], v[68:71], a[248:251]
  v_add_f32 v14, v14, v11
  v_mfma_f32_16x16x32_bf16 a[252:255], v[40:43], v[72:75], 0
  ds_read_b128 v[40:43], v1 offset:38912
  v_mfma_f32_16x16x32_bf16 a[252:255], v[44:47], v[76:79], a[252:255]
  s_waitcnt vmcnt(12) lgkmcnt(1)
  s_barrier
  v_mfma_f32_16x16x32_bf16 v[112:115], v[16:19], a[0:3], 0
  ds_read_b128 v[44:47], v1 offset:39424
  s_add_u32 m0, s25, 16384
  v_mfma_f32_16x16x32_bf16 v[112:115], v[20:23], a[4:7], v[112:115]
  buffer_load_dwordx4 v4, s[8:11], s36 offen offset:0 lds
  v_mfma_f32_16x16x32_bf16 v[112:115], v[24:27], a[8:11], v[112:115]
  v_exp_f32 v8, v124
  v_mfma_f32_16x16x32_bf16 v[112:115], v[28:31], a[12:15], v[112:115]
  v_exp_f32 v9, v125
  v_mfma_f32_16x16x32_bf16 v[112:115], v[32:35], a[16:19], v[112:115]
  v_add_f32 v15, v15, v8
  v_cvt_pk_bf16_f32 v106, v8, v9
  v_mfma_f32_16x16x32_bf16 v[112:115], v[36:39], a[20:23], v[112:115]
  v_add_f32 v15, v15, v9
  s_waitcnt lgkmcnt(0)
  v_mfma_f32_16x16x32_bf16 v[112:115], v[40:43], a[24:27], v[112:115]
  v_exp_f32 v10, v126
  v_mfma_f32_16x16x32_bf16 v[112:115], v[44:47], a[28:31], v[112:115]
  buffer_load_dwordx4 v4, s[8:11], s37 offen offset:1024 lds
  v_mfma_f32_16x16x32_bf16 v[116:119], v[16:19], a[32:35], 0
  v_exp_f32 v11, v127
  v_mfma_f32_16x16x32_bf16 v[116:119], v[20:23], a[36:39], v[116:119]
  v_add_f32 v15, v15, v10
  v_cvt_pk_bf16_f32 v107, v10, v11
  v_mfma_f32_16x16x32_bf16 v[116:119], v[24:27], a[40:43], v[116:119]
  v_add_f32 v15, v15, v11
  v_mfma_f32_16x16x32_bf16 v[116:119], v[28:31], a[44:47], v[116:119]
  v_mfma_f32_16x16x32_bf16 v[116:119], v[32:35], a[48:51], v[116:119]
  v_mfma_f32_16x16x32_bf16 v[116:119], v[36:39], a[52:55], v[116:119]
  buffer_load_dwordx4 v4, s[8:11], s38 offen offset:2048 lds
  v_mfma_f32_16x16x32_bf16 v[116:119], v[40:43], a[56:59], v[116:119]
  v_mfma_f32_16x16x32_bf16 v[116:119], v[44:47], a[60:63], v[116:119]
  v_exp_f32 v8, v112
  v_mfma_f32_16x16x32_bf16 v[120:123], v[16:19], a[64:67], 0
  v_exp_f32 v9, v113
  v_mfma_f32_16x16x32_bf16 v[120:123], v[20:23], a[68:71], v[120:123]
  v_add_f32 v12, v12, v8
  v_cvt_pk_bf16_f32 v84, v8, v9
  v_mfma_f32_16x16x32_bf16 v[120:123], v[24:27], a[72:75], v[120:123]
  v_add_f32 v12, v12, v9
  v_mfma_f32_16x16x32_bf16 v[120:123], v[28:31], a[76:79], v[120:123]
  buffer_load_dwordx4 v4, s[8:11], s39 offen offset:3072 lds
  v_mfma_f32_16x16x32_bf16 v[120:123], v[32:35], a[80:83], v[120:123]
  v_exp_f32 v10, v114
  v_mfma_f32_16x16x32_bf16 v[120:123], v[36:39], a[84:87], v[120:123]
  v_exp_f32 v11, v115
  v_mfma_f32_16x16x32_bf16 v[120:123], v[40:43], a[88:91], v[120:123]
  v_add_f32 v12, v12, v10
  v_cvt_pk_bf16_f32 v85, v10, v11
  v_mfma_f32_16x16x32_bf16 v[120:123], v[44:47], a[92:95], v[120:123]
  v_add_f32 v12, v12, v11
  v_mfma_f32_16x16x32_bf16 v[124:127], v[16:19], a[96:99], 0
  ds_read_b64_tr_b16 v[16:17], v2 offset:40960
  ds_read_b64_tr_b16 v[18:19], v2 offset:43008
  v_mfma_f32_16x16x32_bf16 v[124:127], v[20:23], a[100:103], v[124:127]
  ds_read_b64_tr_b16 v[20:21], v2 offset:45056
  ds_read_b64_tr_b16 v[22:23], v2 offset:47104
  v_mfma_f32_16x16x32_bf16 v[124:127], v[24:27], a[104:107], v[124:127]
  v_mfma_f32_16x16x32_bf16 v[124:127], v[28:31], a[108:111], v[124:127]
  v_mfma_f32_16x16x32_bf16 v[124:127], v[32:35], a[112:115], v[124:127]
  v_mfma_f32_16x16x32_bf16 v[124:127], v[36:39], a[116:119], v[124:127]
  v_exp_f32 v8, v116
  v_mfma_f32_16x16x32_bf16 v[124:127], v[40:43], a[120:123], v[124:127]
  ds_read_b64_tr_b16 v[24:25], v3 offset:40960
  ds_read_b64_tr_b16 v[26:27], v3 offset:43008
  v_mfma_f32_16x16x32_bf16 v[124:127], v[44:47], a[124:127], v[124:127]
  ds_read_b64_tr_b16 v[28:29], v3 offset:45056
  s_waitcnt lgkmcnt(3)
  v_mfma_f32_16x16x32_bf16 v[128:131], v[16:19], v[48:51], 0
  ds_read_b64_tr_b16 v[30:31], v3 offset:47104
  s_add_u32 m0, s25, 24576
  v_mfma_f32_16x16x32_bf16 v[128:131], v[20:23], v[52:55], v[128:131]
  buffer_load_dwordx4 v5, s[12:15], s52 offen offset:0 lds
  v_mfma_f32_16x16x32_bf16 v[132:135], v[16:19], v[56:59], 0
  v_exp_f32 v9, v117
  v_mfma_f32_16x16x32_bf16 v[132:135], v[20:23], v[60:63], v[132:135]
  v_add_f32 v13, v13, v8
  v_cvt_pk_bf16_f32 v92, v8, v9
  v_mfma_f32_16x16x32_bf16 v[136:139], v[16:19], v[64:67], 0
  v_add_f32 v13, v13, v9
  v_mfma_f32_16x16x32_bf16 v[136:139], v[20:23], v[68:71], v[136:139]
  v_exp_f32 v10, v118
  v_mfma_f32_16x16x32_bf16 v[140:143], v[16:19], v[72:75], 0
  ds_read_b64_tr_b16 v[32:33], v2 offset:41472
  ds_read_b64_tr_b16 v[34:35], v2 offset:43520
  v_mfma_f32_16x16x32_bf16 v[140:143], v[20:23], v[76:79], v[140:143]
  ds_read_b64_tr_b16 v[36:37], v2 offset:45568
  s_waitcnt lgkmcnt(3)
  v_mfma_f32_16x16x32_bf16 v[144:147], v[24:27], v[48:51], 0
  ds_read_b64_tr_b16 v[38:39], v2 offset:47616
  buffer_load_dwordx4 v5, s[12:15], s53 offen offset:1024 lds
  v_mfma_f32_16x16x32_bf16 v[144:147], v[28:31], v[52:55], v[144:147]
  v_exp_f32 v11, v119
  v_mfma_f32_16x16x32_bf16 v[148:151], v[24:27], v[56:59], 0
  v_add_f32 v13, v13, v10
  v_cvt_pk_bf16_f32 v93, v10, v11
  v_mfma_f32_16x16x32_bf16 v[148:151], v[28:31], v[60:63], v[148:151]
  v_add_f32 v13, v13, v11
  v_mfma_f32_16x16x32_bf16 v[152:155], v[24:27], v[64:67], 0
  v_mfma_f32_16x16x32_bf16 v[152:155], v[28:31], v[68:71], v[152:155]
  buffer_load_dwordx4 v5, s[12:15], s54 offen offset:2048 lds
  v_mfma_f32_16x16x32_bf16 v[156:159], v[24:27], v[72:75], 0
  ds_read_b64_tr_b16 v[40:41], v3 offset:41472
  ds_read_b64_tr_b16 v[42:43], v3 offset:43520
  v_mfma_f32_16x16x32_bf16 v[156:159], v[28:31], v[76:79], v[156:159]
  ds_read_b64_tr_b16 v[44:45], v3 offset:45568
  s_waitcnt lgkmcnt(3)
  v_mfma_f32_16x16x32_bf16 v[160:163], v[32:35], v[48:51], 0
  ds_read_b64_tr_b16 v[46:47], v3 offset:47616
  v_mfma_f32_16x16x32_bf16 v[160:163], v[36:39], v[52:55], v[160:163]
  v_exp_f32 v8, v120
  v_mfma_f32_16x16x32_bf16 v[164:167], v[32:35], v[56:59], 0
  v_exp_f32 v9, v121
  v_mfma_f32_16x16x32_bf16 v[164:167], v[36:39], v[60:63], v[164:167]
  buffer_load_dwordx4 v5, s[12:15], s55 offen offset:3072 lds
  v_add_f32 v14, v14, v8
  v_mfma_f32_16x16x32_bf16 v[168:171], v[32:35], v[64:67], 0
  ds_read_b128 v[16:19], v1 offset:49152
  s_mov_b32 m0, 139264
  v_mfma_f32_16x16x32_bf16 v[168:171], v[36:39], v[68:71], v[168:171]
  ds_read_b128 v[20:23], v1 offset:49664
  buffer_load_dword v7, s[4:7], 0 offen lds
  v_mfma_f32_16x16x32_bf16 v[172:175], v[32:35], v[72:75], 0
  ds_read_b128 v[24:27], v1 offset:51200
  v_add_u32 v7, 0x8000, v7
  v_mfma_f32_16x16x32_bf16 v[172:175], v[36:39], v[76:79], v[172:175]
  ds_read_b128 v[28:31], v1 offset:51712
  s_waitcnt lgkmcnt(4)
  v_mfma_f32_16x16x32_bf16 v[176:179], v[40:43], v[48:51], 0
  ds_read_b128 v[32:35], v1 offset:53248
  v_cvt_pk_bf16_f32 v100, v8, v9
  v_mfma_f32_16x16x32_bf16 v[176:179], v[44:47], v[52:55], v[176:179]
  ds_read_b128 v[36:39], v1 offset:53760
  v_add_f32 v14, v14, v9
  v_mfma_f32_16x16x32_bf16 v[180:183], v[40:43], v[56:59], 0
  v_exp_f32 v10, v122
  v_mfma_f32_16x16x32_bf16 v[180:183], v[44:47], v[60:63], v[180:183]
  v_exp_f32 v11, v123
  v_mfma_f32_16x16x32_bf16 v[184:187], v[40:43], v[64:67], 0
  v_add_f32 v14, v14, v10
  v_cvt_pk_bf16_f32 v101, v10, v11
  v_mfma_f32_16x16x32_bf16 v[184:187], v[44:47], v[68:71], v[184:187]
  v_add_f32 v14, v14, v11
  v_mfma_f32_16x16x32_bf16 v[188:191], v[40:43], v[72:75], 0
  ds_read_b128 v[40:43], v1 offset:55296
  v_mfma_f32_16x16x32_bf16 v[188:191], v[44:47], v[76:79], v[188:191]
  s_waitcnt vmcnt(13) lgkmcnt(1)
  s_barrier
  v_mfma_f32_16x16x32_bf16 v[112:115], v[16:19], a[0:3], 0
  ds_read_b128 v[44:47], v1 offset:55808
  s_add_u32 m0, s25, 32768
  v_mfma_f32_16x16x32_bf16 v[112:115], v[20:23], a[4:7], v[112:115]
  buffer_load_dwordx4 v4, s[8:11], s40 offen offset:0 lds
  v_mfma_f32_16x16x32_bf16 v[112:115], v[24:27], a[8:11], v[112:115]
  v_exp_f32 v8, v124
  v_mfma_f32_16x16x32_bf16 v[112:115], v[28:31], a[12:15], v[112:115]
  v_exp_f32 v9, v125
  v_mfma_f32_16x16x32_bf16 v[112:115], v[32:35], a[16:19], v[112:115]
  v_add_f32 v15, v15, v8
  v_cvt_pk_bf16_f32 v108, v8, v9
  v_mfma_f32_16x16x32_bf16 v[112:115], v[36:39], a[20:23], v[112:115]
  v_add_f32 v15, v15, v9
  s_waitcnt lgkmcnt(0)
  v_mfma_f32_16x16x32_bf16 v[112:115], v[40:43], a[24:27], v[112:115]
  v_exp_f32 v10, v126
  v_mfma_f32_16x16x32_bf16 v[112:115], v[44:47], a[28:31], v[112:115]
  buffer_load_dwordx4 v4, s[8:11], s41 offen offset:1024 lds
  v_mfma_f32_16x16x32_bf16 v[116:119], v[16:19], a[32:35], 0
  v_exp_f32 v11, v127
  v_mfma_f32_16x16x32_bf16 v[116:119], v[20:23], a[36:39], v[116:119]
  v_add_f32 v15, v15, v10
  v_cvt_pk_bf16_f32 v109, v10, v11
  v_mfma_f32_16x16x32_bf16 v[116:119], v[24:27], a[40:43], v[116:119]
  v_add_f32 v15, v15, v11
  v_mfma_f32_16x16x32_bf16 v[116:119], v[28:31], a[44:47], v[116:119]
  v_mfma_f32_16x16x32_bf16 v[116:119], v[32:35], a[48:51], v[116:119]
  v_mfma_f32_16x16x32_bf16 v[116:119], v[36:39], a[52:55], v[116:119]
  buffer_load_dwordx4 v4, s[8:11], s42 offen offset:2048 lds
  v_mfma_f32_16x16x32_bf16 v[116:119], v[40:43], a[56:59], v[116:119]
  v_mfma_f32_16x16x32_bf16 v[116:119], v[44:47], a[60:63], v[116:119]
  v_exp_f32 v8, v112
  v_mfma_f32_16x16x32_bf16 v[120:123], v[16:19], a[64:67], 0
  v_exp_f32 v9, v113
  v_mfma_f32_16x16x32_bf16 v[120:123], v[20:23], a[68:71], v[120:123]
  v_add_f32 v12, v12, v8
  v_cvt_pk_bf16_f32 v86, v8, v9
  v_mfma_f32_16x16x32_bf16 v[120:123], v[24:27], a[72:75], v[120:123]
  v_add_f32 v12, v12, v9
  v_mfma_f32_16x16x32_bf16 v[120:123], v[28:31], a[76:79], v[120:123]
  buffer_load_dwordx4 v4, s[8:11], s43 offen offset:3072 lds
  v_mfma_f32_16x16x32_bf16 v[120:123], v[32:35], a[80:83], v[120:123]
  v_exp_f32 v10, v114
  v_mfma_f32_16x16x32_bf16 v[120:123], v[36:39], a[84:87], v[120:123]
  v_exp_f32 v11, v115
  v_mfma_f32_16x16x32_bf16 v[120:123], v[40:43], a[88:91], v[120:123]
  v_add_f32 v12, v12, v10
  v_cvt_pk_bf16_f32 v87, v10, v11
  v_mfma_f32_16x16x32_bf16 v[120:123], v[44:47], a[92:95], v[120:123]
  v_add_f32 v12, v12, v11
  v_mfma_f32_16x16x32_bf16 v[124:127], v[16:19], a[96:99], 0
  ds_read_b64_tr_b16 v[16:17], v2 offset:57344
  ds_read_b64_tr_b16 v[18:19], v2 offset:59392
  v_mfma_f32_16x16x32_bf16 v[124:127], v[20:23], a[100:103], v[124:127]
  ds_read_b64_tr_b16 v[20:21], v2 offset:61440
  ds_read_b64_tr_b16 v[22:23], v2 offset:63488
  v_mfma_f32_16x16x32_bf16 v[124:127], v[24:27], a[104:107], v[124:127]
  v_mfma_f32_16x16x32_bf16 v[124:127], v[28:31], a[108:111], v[124:127]
  v_mfma_f32_16x16x32_bf16 v[124:127], v[32:35], a[112:115], v[124:127]
  v_mfma_f32_16x16x32_bf16 v[124:127], v[36:39], a[116:119], v[124:127]
  v_exp_f32 v8, v116
  v_mfma_f32_16x16x32_bf16 v[124:127], v[40:43], a[120:123], v[124:127]
  ds_read_b64_tr_b16 v[24:25], v3 offset:57344
  ds_read_b64_tr_b16 v[26:27], v3 offset:59392
  v_mfma_f32_16x16x32_bf16 v[124:127], v[44:47], a[124:127], v[124:127]
  ds_read_b64_tr_b16 v[28:29], v3 offset:61440
  s_waitcnt lgkmcnt(3)
  v_mfma_f32_16x16x32_bf16 v[192:195], v[16:19], v[48:51], 0
  ds_read_b64_tr_b16 v[30:31], v3 offset:63488
  s_add_u32 m0, s25, 40960
  v_mfma_f32_16x16x32_bf16 v[192:195], v[20:23], v[52:55], v[192:195]
  buffer_load_dwordx4 v5, s[12:15], s56 offen offset:0 lds
  v_mfma_f32_16x16x32_bf16 v[196:199], v[16:19], v[56:59], 0
  v_exp_f32 v9, v117
  v_mfma_f32_16x16x32_bf16 v[196:199], v[20:23], v[60:63], v[196:199]
  v_add_f32 v13, v13, v8
  v_cvt_pk_bf16_f32 v94, v8, v9
  v_mfma_f32_16x16x32_bf16 v[200:203], v[16:19], v[64:67], 0
  v_add_f32 v13, v13, v9
  v_mfma_f32_16x16x32_bf16 v[200:203], v[20:23], v[68:71], v[200:203]
  v_exp_f32 v10, v118
  v_mfma_f32_16x16x32_bf16 v[204:207], v[16:19], v[72:75], 0
  ds_read_b64_tr_b16 v[32:33], v2 offset:57856
  ds_read_b64_tr_b16 v[34:35], v2 offset:59904
  v_mfma_f32_16x16x32_bf16 v[204:207], v[20:23], v[76:79], v[204:207]
  ds_read_b64_tr_b16 v[36:37], v2 offset:61952
  s_waitcnt lgkmcnt(3)
  v_mfma_f32_16x16x32_bf16 v[208:211], v[24:27], v[48:51], 0
  ds_read_b64_tr_b16 v[38:39], v2 offset:64000
  buffer_load_dwordx4 v5, s[12:15], s57 offen offset:1024 lds
  v_mfma_f32_16x16x32_bf16 v[208:211], v[28:31], v[52:55], v[208:211]
  v_exp_f32 v11, v119
  v_mfma_f32_16x16x32_bf16 v[212:215], v[24:27], v[56:59], 0
  v_add_f32 v13, v13, v10
  v_cvt_pk_bf16_f32 v95, v10, v11
  v_mfma_f32_16x16x32_bf16 v[212:215], v[28:31], v[60:63], v[212:215]
  v_add_f32 v13, v13, v11
  v_mfma_f32_16x16x32_bf16 v[216:219], v[24:27], v[64:67], 0
  v_mfma_f32_16x16x32_bf16 v[216:219], v[28:31], v[68:71], v[216:219]
  buffer_load_dwordx4 v5, s[12:15], s58 offen offset:2048 lds
  v_mfma_f32_16x16x32_bf16 v[220:223], v[24:27], v[72:75], 0
  ds_read_b64_tr_b16 v[40:41], v3 offset:57856
  ds_read_b64_tr_b16 v[42:43], v3 offset:59904
  v_mfma_f32_16x16x32_bf16 v[220:223], v[28:31], v[76:79], v[220:223]
  ds_read_b64_tr_b16 v[44:45], v3 offset:61952
  s_waitcnt lgkmcnt(3)
  v_mfma_f32_16x16x32_bf16 v[224:227], v[32:35], v[48:51], 0
  ds_read_b64_tr_b16 v[46:47], v3 offset:64000
  v_mfma_f32_16x16x32_bf16 v[224:227], v[36:39], v[52:55], v[224:227]
  v_exp_f32 v8, v120
  v_mfma_f32_16x16x32_bf16 v[228:231], v[32:35], v[56:59], 0
  v_exp_f32 v9, v121
  v_mfma_f32_16x16x32_bf16 v[228:231], v[36:39], v[60:63], v[228:231]
  buffer_load_dwordx4 v5, s[12:15], s59 offen offset:3072 lds
  v_add_f32 v14, v14, v8
  v_mfma_f32_16x16x32_bf16 v[232:235], v[32:35], v[64:67], 0
  ds_read_b128 v[16:19], v1 offset:0
  v_cvt_pk_bf16_f32 v102, v8, v9
  v_mfma_f32_16x16x32_bf16 v[232:235], v[36:39], v[68:71], v[232:235]
  ds_read_b128 v[20:23], v1 offset:512
  v_add_f32 v14, v14, v9
  v_mfma_f32_16x16x32_bf16 v[236:239], v[32:35], v[72:75], 0
  ds_read_b128 v[24:27], v1 offset:2048
  v_mfma_f32_16x16x32_bf16 v[236:239], v[36:39], v[76:79], v[236:239]
  ds_read_b128 v[28:31], v1 offset:2560
  s_waitcnt lgkmcnt(4)
  v_mfma_f32_16x16x32_bf16 v[240:243], v[40:43], v[48:51], 0
  ds_read_b128 v[32:35], v1 offset:4096
  v_mfma_f32_16x16x32_bf16 v[240:243], v[44:47], v[52:55], v[240:243]
  ds_read_b128 v[36:39], v1 offset:4608
  v_mfma_f32_16x16x32_bf16 v[244:247], v[40:43], v[56:59], 0
  v_exp_f32 v10, v122
  v_mfma_f32_16x16x32_bf16 v[244:247], v[44:47], v[60:63], v[244:247]
  v_exp_f32 v11, v123
  v_mfma_f32_16x16x32_bf16 v[248:251], v[40:43], v[64:67], 0
  v_add_f32 v14, v14, v10
  v_cvt_pk_bf16_f32 v103, v10, v11
  v_mfma_f32_16x16x32_bf16 v[248:251], v[44:47], v[68:71], v[248:251]
  v_add_f32 v14, v14, v11
  v_mfma_f32_16x16x32_bf16 v[252:255], v[40:43], v[72:75], 0
  ds_read_b128 v[40:43], v1 offset:6144
  v_mfma_f32_16x16x32_bf16 v[252:255], v[44:47], v[76:79], v[252:255]
  s_mov_b32 s26, 7
.p2align 6
L_loop:
  s_waitcnt vmcnt(13) lgkmcnt(1)
  s_barrier
  v_mfma_f32_16x16x32_bf16 v[112:115], v[16:19], a[0:3], 0
  ds_read_b128 v[44:47], v1 offset:6656
  s_add_u32 m0, s25, 49152
  v_mfma_f32_16x16x32_bf16 v[112:115], v[20:23], a[4:7], v[112:115]
  buffer_load_dwordx4 v4, s[8:11], s44 offen offset:0 lds
  v_mfma_f32_16x16x32_bf16 v[112:115], v[24:27], a[8:11], v[112:115]
  v_exp_f32 v8, v124
  v_mfma_f32_16x16x32_bf16 v[112:115], v[28:31], a[12:15], v[112:115]
  v_exp_f32 v9, v125
  v_mfma_f32_16x16x32_bf16 v[112:115], v[32:35], a[16:19], v[112:115]
  v_add_f32 v15, v15, v8
  v_cvt_pk_bf16_f32 v110, v8, v9
  v_mfma_f32_16x16x32_bf16 v[112:115], v[36:39], a[20:23], v[112:115]
  v_add_f32 v15, v15, v9
  s_waitcnt lgkmcnt(0)
  v_mfma_f32_16x16x32_bf16 v[112:115], v[40:43], a[24:27], v[112:115]
  v_exp_f32 v10, v126
  v_mfma_f32_16x16x32_bf16 v[112:115], v[44:47], a[28:31], v[112:115]
  buffer_load_dwordx4 v4, s[8:11], s45 offen offset:1024 lds
  v_mfma_f32_16x16x32_bf16 v[116:119], v[16:19], a[32:35], 0
  v_exp_f32 v11, v127
  v_mfma_f32_16x16x32_bf16 v[116:119], v[20:23], a[36:39], v[116:119]
  v_add_f32 v15, v15, v10
  v_cvt_pk_bf16_f32 v111, v10, v11
  v_mfma_f32_16x16x32_bf16 v[116:119], v[24:27], a[40:43], v[116:119]
  v_add_f32 v15, v15, v11
  v_mfma_f32_16x16x32_bf16 v[116:119], v[28:31], a[44:47], v[116:119]
  v_mfma_f32_16x16x32_bf16 v[116:119], v[32:35], a[48:51], v[116:119]
  v_mfma_f32_16x16x32_bf16 v[116:119], v[36:39], a[52:55], v[116:119]
  buffer_load_dwordx4 v4, s[8:11], s46 offen offset:2048 lds
  v_mfma_f32_16x16x32_bf16 v[116:119], v[40:43], a[56:59], v[116:119]
  v_mfma_f32_16x16x32_bf16 v[116:119], v[44:47], a[60:63], v[116:119]
  v_exp_f32 v8, v112
  v_mfma_f32_16x16x32_bf16 v[120:123], v[16:19], a[64:67], 0
  v_exp_f32 v9, v113
  v_mfma_f32_16x16x32_bf16 v[120:123], v[20:23], a[68:71], v[120:123]
  v_add_f32 v12, v12, v8
  v_cvt_pk_bf16_f32 v48, v8, v9
  v_mfma_f32_16x16x32_bf16 v[120:123], v[24:27], a[72:75], v[120:123]
  v_add_f32 v12, v12, v9
  v_mfma_f32_16x16x32_bf16 v[120:123], v[28:31], a[76:79], v[120:123]
  buffer_load_dwordx4 v4, s[8:11], s47 offen offset:3072 lds
  v_mfma_f32_16x16x32_bf16 v[120:123], v[32:35], a[80:83], v[120:123]
  v_add_u32 v4, 0x8000, v4
  v_mfma_f32_16x16x32_bf16 v[120:123], v[36:39], a[84:87], v[120:123]
  v_exp_f32 v10, v114
  v_mfma_f32_16x16x32_bf16 v[120:123], v[40:43], a[88:91], v[120:123]
  v_exp_f32 v11, v115
  v_mfma_f32_16x16x32_bf16 v[120:123], v[44:47], a[92:95], v[120:123]
  v_add_f32 v12, v12, v10
  v_cvt_pk_bf16_f32 v49, v10, v11
  v_mfma_f32_16x16x32_bf16 v[124:127], v[16:19], a[96:99], 0
  ds_read_b64_tr_b16 v[16:17], v2 offset:8192
  ds_read_b64_tr_b16 v[18:19], v2 offset:10240
  v_mfma_f32_16x16x32_bf16 v[124:127], v[20:23], a[100:103], v[124:127]
  ds_read_b64_tr_b16 v[20:21], v2 offset:12288
  ds_read_b64_tr_b16 v[22:23], v2 offset:14336
  v_mfma_f32_16x16x32_bf16 v[124:127], v[24:27], a[104:107], v[124:127]
  v_add_f32 v12, v12, v11
  v_mfma_f32_16x16x32_bf16 v[124:127], v[28:31], a[108:111], v[124:127]
  v_mfma_f32_16x16x32_bf16 v[124:127], v[32:35], a[112:115], v[124:127]
  v_mfma_f32_16x16x32_bf16 v[124:127], v[36:39], a[116:119], v[124:127]
  v_exp_f32 v8, v116
  v_mfma_f32_16x16x32_bf16 v[124:127], v[40:43], a[120:123], v[124:127]
  ds_read_b64_tr_b16 v[24:25], v3 offset:8192
  ds_read_b64_tr_b16 v[26:27], v3 offset:10240
  v_mfma_f32_16x16x32_bf16 v[124:127], v[44:47], a[124:127], v[124:127]
  ds_read_b64_tr_b16 v[28:29], v3 offset:12288
  s_waitcnt lgkmcnt(3)
  v_mfma_f32_16x16x32_bf16 a[128:131], v[16:19], v[80:83], a[128:131]
  ds_read_b64_tr_b16 v[30:31], v3 offset:14336
  s_add_u32 m0, s25, 57344
  v_mfma_f32_16x16x32_bf16 a[128:131], v[20:23], v[84:87], a[128:131]
  buffer_load_dwordx4 v5, s[12:15], s60 offen offset:0 lds
  v_mfma_f32_16x16x32_bf16 a[132:135], v[16:19], v[88:91], a[132:135]
  v_exp_f32 v9, v117
  v_mfma_f32_16x16x32_bf16 a[132:135], v[20:23], v[92:95], a[132:135]
  v_add_f32 v13, v13, v8
  v_cvt_pk_bf16_f32 v56, v8, v9
  v_mfma_f32_16x16x32_bf16 a[136:139], v[16:19], v[96:99], a[136:139]
  v_add_f32 v13, v13, v9
  v_mfma_f32_16x16x32_bf16 a[136:139], v[20:23], v[100:103], a[136:139]
  v_exp_f32 v10, v118
  v_mfma_f32_16x16x32_bf16 a[140:143], v[16:19], v[104:107], a[140:143]
  ds_read_b64_tr_b16 v[32:33], v2 offset:8704
  ds_read_b64_tr_b16 v[34:35], v2 offset:10752
  v_mfma_f32_16x16x32_bf16 a[140:143], v[20:23], v[108:111], a[140:143]
  ds_read_b64_tr_b16 v[36:37], v2 offset:12800
  s_waitcnt lgkmcnt(3)
  v_mfma_f32_16x16x32_bf16 a[144:147], v[24:27], v[80:83], a[144:147]
  ds_read_b64_tr_b16 v[38:39], v2 offset:14848
  buffer_load_dwordx4 v5, s[12:15], s61 offen offset:1024 lds
  v_mfma_f32_16x16x32_bf16 a[144:147], v[28:31], v[84:87], a[144:147]
  v_exp_f32 v11, v119
  v_mfma_f32_16x16x32_bf16 a[148:151], v[24:27], v[88:91], a[148:151]
  v_add_f32 v13, v13, v10
  v_cvt_pk_bf16_f32 v57, v10, v11
  v_mfma_f32_16x16x32_bf16 a[148:151], v[28:31], v[92:95], a[148:151]
  v_add_f32 v13, v13, v11
  v_mfma_f32_16x16x32_bf16 a[152:155], v[24:27], v[96:99], a[152:155]
  v_mfma_f32_16x16x32_bf16 a[152:155], v[28:31], v[100:103], a[152:155]
  buffer_load_dwordx4 v5, s[12:15], s62 offen offset:2048 lds
  v_mfma_f32_16x16x32_bf16 a[156:159], v[24:27], v[104:107], a[156:159]
  ds_read_b64_tr_b16 v[40:41], v3 offset:8704
  ds_read_b64_tr_b16 v[42:43], v3 offset:10752
  v_mfma_f32_16x16x32_bf16 a[156:159], v[28:31], v[108:111], a[156:159]
  ds_read_b64_tr_b16 v[44:45], v3 offset:12800
  s_waitcnt lgkmcnt(3)
  v_mfma_f32_16x16x32_bf16 a[160:163], v[32:35], v[80:83], a[160:163]
  ds_read_b64_tr_b16 v[46:47], v3 offset:14848
  v_mfma_f32_16x16x32_bf16 a[160:163], v[36:39], v[84:87], a[160:163]
  v_exp_f32 v8, v120
  v_mfma_f32_16x16x32_bf16 a[164:167], v[32:35], v[88:91], a[164:167]
  v_exp_f32 v9, v121
  v_mfma_f32_16x16x32_bf16 a[164:167], v[36:39], v[92:95], a[164:167]
  buffer_load_dwordx4 v5, s[12:15], s63 offen offset:3072 lds
  v_add_f32 v14, v14, v8
  v_mfma_f32_16x16x32_bf16 a[168:171], v[32:35], v[96:99], a[168:171]
  ds_read_b128 v[16:19], v1 offset:16384
  v_add_u32 v5, 0x8000, v5
  v_mfma_f32_16x16x32_bf16 a[168:171], v[36:39], v[100:103], a[168:171]
  ds_read_b128 v[20:23], v1 offset:16896
  v_cvt_pk_bf16_f32 v64, v8, v9
  v_mfma_f32_16x16x32_bf16 a[172:175], v[32:35], v[104:107], a[172:175]
  ds_read_b128 v[24:27], v1 offset:18432
  v_add_f32 v14, v14, v9
  v_mfma_f32_16x16x32_bf16 a[172:175], v[36:39], v[108:111], a[172:175]
  ds_read_b128 v[28:31], v1 offset:18944
  s_waitcnt lgkmcnt(4)
  v_mfma_f32_16x16x32_bf16 a[176:179], v[40:43], v[80:83], a[176:179]
  ds_read_b128 v[32:35], v1 offset:20480
  v_mfma_f32_16x16x32_bf16 a[176:179], v[44:47], v[84:87], a[176:179]
  ds_read_b128 v[36:39], v1 offset:20992
  v_mfma_f32_16x16x32_bf16 a[180:183], v[40:43], v[88:91], a[180:183]
  v_exp_f32 v10, v122
  v_mfma_f32_16x16x32_bf16 a[180:183], v[44:47], v[92:95], a[180:183]
  v_exp_f32 v11, v123
  v_mfma_f32_16x16x32_bf16 a[184:187], v[40:43], v[96:99], a[184:187]
  v_add_f32 v14, v14, v10
  v_cvt_pk_bf16_f32 v65, v10, v11
  v_mfma_f32_16x16x32_bf16 a[184:187], v[44:47], v[100:103], a[184:187]
  v_add_f32 v14, v14, v11
  v_mfma_f32_16x16x32_bf16 a[188:191], v[40:43], v[104:107], a[188:191]
  ds_read_b128 v[40:43], v1 offset:22528
  v_mfma_f32_16x16x32_bf16 a[188:191], v[44:47], v[108:111], a[188:191]
  s_waitcnt vmcnt(12) lgkmcnt(1)
  s_barrier
  v_mfma_f32_16x16x32_bf16 v[112:115], v[16:19], a[0:3], 0
  ds_read_b128 v[44:47], v1 offset:23040
  s_add_u32 m0, s25, 0
  v_mfma_f32_16x16x32_bf16 v[112:115], v[20:23], a[4:7], v[112:115]
  buffer_load_dwordx4 v4, s[8:11], s32 offen offset:0 lds
  v_mfma_f32_16x16x32_bf16 v[112:115], v[24:27], a[8:11], v[112:115]
  v_exp_f32 v8, v124
  v_mfma_f32_16x16x32_bf16 v[112:115], v[28:31], a[12:15], v[112:115]
  v_exp_f32 v9, v125
  v_mfma_f32_16x16x32_bf16 v[112:115], v[32:35], a[16:19], v[112:115]
  v_add_f32 v15, v15, v8
  v_cvt_pk_bf16_f32 v72, v8, v9
  v_mfma_f32_16x16x32_bf16 v[112:115], v[36:39], a[20:23], v[112:115]
  v_add_f32 v15, v15, v9
  s_waitcnt lgkmcnt(0)
  v_mfma_f32_16x16x32_bf16 v[112:115], v[40:43], a[24:27], v[112:115]
  v_exp_f32 v10, v126
  v_mfma_f32_16x16x32_bf16 v[112:115], v[44:47], a[28:31], v[112:115]
  buffer_load_dwordx4 v4, s[8:11], s33 offen offset:1024 lds
  v_mfma_f32_16x16x32_bf16 v[116:119], v[16:19], a[32:35], 0
  v_exp_f32 v11, v127
  v_mfma_f32_16x16x32_bf16 v[116:119], v[20:23], a[36:39], v[116:119]
  v_add_f32 v15, v15, v10
  v_cvt_pk_bf16_f32 v73, v10, v11
  v_mfma_f32_16x16x32_bf16 v[116:119], v[24:27], a[40:43], v[116:119]
  v_add_f32 v15, v15, v11
  v_mfma_f32_16x16x32_bf16 v[116:119], v[28:31], a[44:47], v[116:119]
  v_mfma_f32_16x16x32_bf16 v[116:119], v[32:35], a[48:51], v[116:119]
  v_mfma_f32_16x16x32_bf16 v[116:119], v[36:39], a[52:55], v[116:119]
  buffer_load_dwordx4 v4, s[8:11], s34 offen offset:2048 lds
  v_mfma_f32_16x16x32_bf16 v[116:119], v[40:43], a[56:59], v[116:119]
  v_mfma_f32_16x16x32_bf16 v[116:119], v[44:47], a[60:63], v[116:119]
  v_exp_f32 v8, v112
  v_mfma_f32_16x16x32_bf16 v[120:123], v[16:19], a[64:67], 0
  v_exp_f32 v9, v113
  v_mfma_f32_16x16x32_bf16 v[120:123], v[20:23], a[68:71], v[120:123]
  v_add_f32 v12, v12, v8
  v_cvt_pk_bf16_f32 v50, v8, v9
  v_mfma_f32_16x16x32_bf16 v[120:123], v[24:27], a[72:75], v[120:123]
  v_add_f32 v12, v12, v9
  v_mfma_f32_16x16x32_bf16 v[120:123], v[28:31], a[76:79], v[120:123]
  buffer_load_dwordx4 v4, s[8:11], s35 offen offset:3072 lds
  v_mfma_f32_16x16x32_bf16 v[120:123], v[32:35], a[80:83], v[120:123]
  v_exp_f32 v10, v114
  v_mfma_f32_16x16x32_bf16 v[120:123], v[36:39], a[84:87], v[120:123]
  v_exp_f32 v11, v115
  v_mfma_f32_16x16x32_bf16 v[120:123], v[40:43], a[88:91], v[120:123]
  v_add_f32 v12, v12, v10
  v_cvt_pk_bf16_f32 v51, v10, v11
  v_mfma_f32_16x16x32_bf16 v[120:123], v[44:47], a[92:95], v[120:123]
  v_add_f32 v12, v12, v11
  v_mfma_f32_16x16x32_bf16 v[124:127], v[16:19], a[96:99], 0
  ds_read_b64_tr_b16 v[16:17], v2 offset:24576
  ds_read_b64_tr_b16 v[18:19], v2 offset:26624
  v_mfma_f32_16x16x32_bf16 v[124:127], v[20:23], a[100:103], v[124:127]
  ds_read_b64_tr_b16 v[20:21], v2 offset:28672
  ds_read_b64_tr_b16 v[22:23], v2 offset:30720
  v_mfma_f32_16x16x32_bf16 v[124:127], v[24:27], a[104:107], v[124:127]
  v_mfma_f32_16x16x32_bf16 v[124:127], v[28:31], a[108:111], v[124:127]
  v_mfma_f32_16x16x32_bf16 v[124:127], v[32:35], a[112:115], v[124:127]
  v_mfma_f32_16x16x32_bf16 v[124:127], v[36:39], a[116:119], v[124:127]
  v_exp_f32 v8, v116
  v_mfma_f32_16x16x32_bf16 v[124:127], v[40:43], a[120:123], v[124:127]
  ds_read_b64_tr_b16 v[24:25], v3 offset:24576
  ds_read_b64_tr_b16 v[26:27], v3 offset:26624
  v_mfma_f32_16x16x32_bf16 v[124:127], v[44:47], a[124:127], v[124:127]
  ds_read_b64_tr_b16 v[28:29], v3 offset:28672
  s_waitcnt lgkmcnt(3)
  v_mfma_f32_16x16x32_bf16 a[192:195], v[16:19], v[80:83], a[192:195]
  ds_read_b64_tr_b16 v[30:31], v3 offset:30720
  s_add_u32 m0, s25, 8192
  v_mfma_f32_16x16x32_bf16 a[192:195], v[20:23], v[84:87], a[192:195]
  buffer_load_dwordx4 v5, s[12:15], s48 offen offset:0 lds
  v_mfma_f32_16x16x32_bf16 a[196:199], v[16:19], v[88:91], a[196:199]
  v_exp_f32 v9, v117
  v_mfma_f32_16x16x32_bf16 a[196:199], v[20:23], v[92:95], a[196:199]
  v_add_f32 v13, v13, v8
  v_cvt_pk_bf16_f32 v58, v8, v9
  v_mfma_f32_16x16x32_bf16 a[200:203], v[16:19], v[96:99], a[200:203]
  v_add_f32 v13, v13, v9
  v_mfma_f32_16x16x32_bf16 a[200:203], v[20:23], v[100:103], a[200:203]
  v_exp_f32 v10, v118
  v_mfma_f32_16x16x32_bf16 a[204:207], v[16:19], v[104:107], a[204:207]
  ds_read_b64_tr_b16 v[32:33], v2 offset:25088
  ds_read_b64_tr_b16 v[34:35], v2 offset:27136
  v_mfma_f32_16x16x32_bf16 a[204:207], v[20:23], v[108:111], a[204:207]
  ds_read_b64_tr_b16 v[36:37], v2 offset:29184
  s_waitcnt lgkmcnt(3)
  v_mfma_f32_16x16x32_bf16 a[208:211], v[24:27], v[80:83], a[208:211]
  ds_read_b64_tr_b16 v[38:39], v2 offset:31232
  buffer_load_dwordx4 v5, s[12:15], s49 offen offset:1024 lds
  v_mfma_f32_16x16x32_bf16 a[208:211], v[28:31], v[84:87], a[208:211]
  v_exp_f32 v11, v119
  v_mfma_f32_16x16x32_bf16 a[212:215], v[24:27], v[88:91], a[212:215]
  v_add_f32 v13, v13, v10
  v_cvt_pk_bf16_f32 v59, v10, v11
  v_mfma_f32_16x16x32_bf16 a[212:215], v[28:31], v[92:95], a[212:215]
  v_add_f32 v13, v13, v11
  v_mfma_f32_16x16x32_bf16 a[216:219], v[24:27], v[96:99], a[216:219]
  v_mfma_f32_16x16x32_bf16 a[216:219], v[28:31], v[100:103], a[216:219]
  buffer_load_dwordx4 v5, s[12:15], s50 offen offset:2048 lds
  v_mfma_f32_16x16x32_bf16 a[220:223], v[24:27], v[104:107], a[220:223]
  ds_read_b64_tr_b16 v[40:41], v3 offset:25088
  ds_read_b64_tr_b16 v[42:43], v3 offset:27136
  v_mfma_f32_16x16x32_bf16 a[220:223], v[28:31], v[108:111], a[220:223]
  ds_read_b64_tr_b16 v[44:45], v3 offset:29184
  s_waitcnt lgkmcnt(3)
  v_mfma_f32_16x16x32_bf16 a[224:227], v[32:35], v[80:83], a[224:227]
  ds_read_b64_tr_b16 v[46:47], v3 offset:31232
  v_mfma_f32_16x16x32_bf16 a[224:227], v[36:39], v[84:87], a[224:227]
  v_exp_f32 v8, v120
  v_mfma_f32_16x16x32_bf16 a[228:231], v[32:35], v[88:91], a[228:231]
  v_exp_f32 v9, v121
  v_mfma_f32_16x16x32_bf16 a[228:231], v[36:39], v[92:95], a[228:231]
  buffer_load_dwordx4 v5, s[12:15], s51 offen offset:3072 lds
  v_add_f32 v14, v14, v8
  v_mfma_f32_16x16x32_bf16 a[232:235], v[32:35], v[96:99], a[232:235]
  ds_read_b128 v[16:19], v1 offset:32768
  v_cvt_pk_bf16_f32 v66, v8, v9
  v_mfma_f32_16x16x32_bf16 a[232:235], v[36:39], v[100:103], a[232:235]
  ds_read_b128 v[20:23], v1 offset:33280
  v_add_f32 v14, v14, v9
  v_mfma_f32_16x16x32_bf16 a[236:239], v[32:35], v[104:107], a[236:239]
  ds_read_b128 v[24:27], v1 offset:34816
  v_mfma_f32_16x16x32_bf16 a[236:239], v[36:39], v[108:111], a[236:239]
  ds_read_b128 v[28:31], v1 offset:35328
  s_waitcnt lgkmcnt(4)
  v_mfma_f32_16x16x32_bf16 a[240:243], v[40:43], v[80:83], a[240:243]
  ds_read_b128 v[32:35], v1 offset:36864
  v_mfma_f32_16x16x32_bf16 a[240:243], v[44:47], v[84:87], a[240:243]
  ds_read_b128 v[36:39], v1 offset:37376
  v_mfma_f32_16x16x32_bf16 a[244:247], v[40:43], v[88:91], a[244:247]
  v_exp_f32 v10, v122
  v_mfma_f32_16x16x32_bf16 a[244:247], v[44:47], v[92:95], a[244:247]
  v_exp_f32 v11, v123
  v_mfma_f32_16x16x32_bf16 a[248:251], v[40:43], v[96:99], a[248:251]
  v_add_f32 v14, v14, v10
  v_cvt_pk_bf16_f32 v67, v10, v11
  v_mfma_f32_16x16x32_bf16 a[248:251], v[44:47], v[100:103], a[248:251]
  v_add_f32 v14, v14, v11
  v_mfma_f32_16x16x32_bf16 a[252:255], v[40:43], v[104:107], a[252:255]
  ds_read_b128 v[40:43], v1 offset:38912
  v_mfma_f32_16x16x32_bf16 a[252:255], v[44:47], v[108:111], a[252:255]
  s_waitcnt vmcnt(12) lgkmcnt(1)
  s_barrier
  v_mfma_f32_16x16x32_bf16 v[112:115], v[16:19], a[0:3], 0
  ds_read_b128 v[44:47], v1 offset:39424
  s_add_u32 m0, s25, 16384
  v_mfma_f32_16x16x32_bf16 v[112:115], v[20:23], a[4:7], v[112:115]
  buffer_load_dwordx4 v4, s[8:11], s36 offen offset:0 lds
  v_mfma_f32_16x16x32_bf16 v[112:115], v[24:27], a[8:11], v[112:115]
  v_exp_f32 v8, v124
  v_mfma_f32_16x16x32_bf16 v[112:115], v[28:31], a[12:15], v[112:115]
  v_exp_f32 v9, v125
  v_mfma_f32_16x16x32_bf16 v[112:115], v[32:35], a[16:19], v[112:115]
  v_add_f32 v15, v15, v8
  v_cvt_pk_bf16_f32 v74, v8, v9
  v_mfma_f32_16x16x32_bf16 v[112:115], v[36:39], a[20:23], v[112:115]
  v_add_f32 v15, v15, v9
  s_waitcnt lgkmcnt(0)
  v_mfma_f32_16x16x32_bf16 v[112:115], v[40:43], a[24:27], v[112:115]
  v_exp_f32 v10, v126
  v_mfma_f32_16x16x32_bf16 v[112:115], v[44:47], a[28:31], v[112:115]
  buffer_load_dwordx4 v4, s[8:11], s37 offen offset:1024 lds
  v_mfma_f32_16x16x32_bf16 v[116:119], v[16:19], a[32:35], 0
  v_exp_f32 v11, v127
  v_mfma_f32_16x16x32_bf16 v[116:119], v[20:23], a[36:39], v[116:119]
  v_add_f32 v15, v15, v10
  v_cvt_pk_bf16_f32 v75, v10, v11
  v_mfma_f32_16x16x32_bf16 v[116:119], v[24:27], a[40:43], v[116:119]
  v_add_f32 v15, v15, v11
  v_mfma_f32_16x16x32_bf16 v[116:119], v[28:31], a[44:47], v[116:119]
  v_mfma_f32_16x16x32_bf16 v[116:119], v[32:35], a[48:51], v[116:119]
  v_mfma_f32_16x16x32_bf16 v[116:119], v[36:39], a[52:55], v[116:119]
  buffer_load_dwordx4 v4, s[8:11], s38 offen offset:2048 lds
  v_mfma_f32_16x16x32_bf16 v[116:119], v[40:43], a[56:59], v[116:119]
  v_mfma_f32_16x16x32_bf16 v[116:119], v[44:47], a[60:63], v[116:119]
  v_exp_f32 v8, v112
  v_mfma_f32_16x16x32_bf16 v[120:123], v[16:19], a[64:67], 0
  v_exp_f32 v9, v113
  v_mfma_f32_16x16x32_bf16 v[120:123], v[20:23], a[68:71], v[120:123]
  v_add_f32 v12, v12, v8
  v_cvt_pk_bf16_f32 v52, v8, v9
  v_mfma_f32_16x16x32_bf16 v[120:123], v[24:27], a[72:75], v[120:123]
  v_add_f32 v12, v12, v9
  v_mfma_f32_16x16x32_bf16 v[120:123], v[28:31], a[76:79], v[120:123]
  buffer_load_dwordx4 v4, s[8:11], s39 offen offset:3072 lds
  v_mfma_f32_16x16x32_bf16 v[120:123], v[32:35], a[80:83], v[120:123]
  v_exp_f32 v10, v114
  v_mfma_f32_16x16x32_bf16 v[120:123], v[36:39], a[84:87], v[120:123]
  v_exp_f32 v11, v115
  v_mfma_f32_16x16x32_bf16 v[120:123], v[40:43], a[88:91], v[120:123]
  v_add_f32 v12, v12, v10
  v_cvt_pk_bf16_f32 v53, v10, v11
  v_mfma_f32_16x16x32_bf16 v[120:123], v[44:47], a[92:95], v[120:123]
  v_add_f32 v12, v12, v11
  v_mfma_f32_16x16x32_bf16 v[124:127], v[16:19], a[96:99], 0
  ds_read_b64_tr_b16 v[16:17], v2 offset:40960
  ds_read_b64_tr_b16 v[18:19], v2 offset:43008
  v_mfma_f32_16x16x32_bf16 v[124:127], v[20:23], a[100:103], v[124:127]
  ds_read_b64_tr_b16 v[20:21], v2 offset:45056
  ds_read_b64_tr_b16 v[22:23], v2 offset:47104
  v_mfma_f32_16x16x32_bf16 v[124:127], v[24:27], a[104:107], v[124:127]
  v_mfma_f32_16x16x32_bf16 v[124:127], v[28:31], a[108:111], v[124:127]
  v_mfma_f32_16x16x32_bf16 v[124:127], v[32:35], a[112:115], v[124:127]
  v_mfma_f32_16x16x32_bf16 v[124:127], v[36:39], a[116:119], v[124:127]
  v_exp_f32 v8, v116
  v_mfma_f32_16x16x32_bf16 v[124:127], v[40:43], a[120:123], v[124:127]
  ds_read_b64_tr_b16 v[24:25], v3 offset:40960
  ds_read_b64_tr_b16 v[26:27], v3 offset:43008
  v_mfma_f32_16x16x32_bf16 v[124:127], v[44:47], a[124:127], v[124:127]
  ds_read_b64_tr_b16 v[28:29], v3 offset:45056
  s_waitcnt lgkmcnt(3)
  v_mfma_f32_16x16x32_bf16 v[128:131], v[16:19], v[80:83], v[128:131]
  ds_read_b64_tr_b16 v[30:31], v3 offset:47104
  s_add_u32 m0, s25, 24576
  v_mfma_f32_16x16x32_bf16 v[128:131], v[20:23], v[84:87], v[128:131]
  buffer_load_dwordx4 v5, s[12:15], s52 offen offset:0 lds
  v_mfma_f32_16x16x32_bf16 v[132:135], v[16:19], v[88:91], v[132:135]
  v_exp_f32 v9, v117
  v_mfma_f32_16x16x32_bf16 v[132:135], v[20:23], v[92:95], v[132:135]
  v_add_f32 v13, v13, v8
  v_cvt_pk_bf16_f32 v60, v8, v9
  v_mfma_f32_16x16x32_bf16 v[136:139], v[16:19], v[96:99], v[136:139]
  v_add_f32 v13, v13, v9
  v_mfma_f32_16x16x32_bf16 v[136:139], v[20:23], v[100:103], v[136:139]
  v_exp_f32 v10, v118
  v_mfma_f32_16x16x32_bf16 v[140:143], v[16:19], v[104:107], v[140:143]
  ds_read_b64_tr_b16 v[32:33], v2 offset:41472
  ds_read_b64_tr_b16 v[34:35], v2 offset:43520
  v_mfma_f32_16x16x32_bf16 v[140:143], v[20:23], v[108:111], v[140:143]
  ds_read_b64_tr_b16 v[36:37], v2 offset:45568
  s_waitcnt lgkmcnt(3)
  v_mfma_f32_16x16x32_bf16 v[144:147], v[24:27], v[80:83], v[144:147]
  ds_read_b64_tr_b16 v[38:39], v2 offset:47616
  buffer_load_dwordx4 v5, s[12:15], s53 offen offset:1024 lds
  v_mfma_f32_16x16x32_bf16 v[144:147], v[28:31], v[84:87], v[144:147]
  v_exp_f32 v11, v119
  v_mfma_f32_16x16x32_bf16 v[148:151], v[24:27], v[88:91], v[148:151]
  v_add_f32 v13, v13, v10
  v_cvt_pk_bf16_f32 v61, v10, v11
  v_mfma_f32_16x16x32_bf16 v[148:151], v[28:31], v[92:95], v[148:151]
  v_add_f32 v13, v13, v11
  v_mfma_f32_16x16x32_bf16 v[152:155], v[24:27], v[96:99], v[152:155]
  v_mfma_f32_16x16x32_bf16 v[152:155], v[28:31], v[100:103], v[152:155]
  buffer_load_dwordx4 v5, s[12:15], s54 offen offset:2048 lds
  v_mfma_f32_16x16x32_bf16 v[156:159], v[24:27], v[104:107], v[156:159]
  ds_read_b64_tr_b16 v[40:41], v3 offset:41472
  ds_read_b64_tr_b16 v[42:43], v3 offset:43520
  v_mfma_f32_16x16x32_bf16 v[156:159], v[28:31], v[108:111], v[156:159]
  ds_read_b64_tr_b16 v[44:45], v3 offset:45568
  s_waitcnt lgkmcnt(3)
  v_mfma_f32_16x16x32_bf16 v[160:163], v[32:35], v[80:83], v[160:163]
  ds_read_b64_tr_b16 v[46:47], v3 offset:47616
  v_mfma_f32_16x16x32_bf16 v[160:163], v[36:39], v[84:87], v[160:163]
  v_exp_f32 v8, v120
  v_mfma_f32_16x16x32_bf16 v[164:167], v[32:35], v[88:91], v[164:167]
  v_exp_f32 v9, v121
  v_mfma_f32_16x16x32_bf16 v[164:167], v[36:39], v[92:95], v[164:167]
  buffer_load_dwordx4 v5, s[12:15], s55 offen offset:3072 lds
  v_add_f32 v14, v14, v8
  v_mfma_f32_16x16x32_bf16 v[168:171], v[32:35], v[96:99], v[168:171]
  ds_read_b128 v[16:19], v1 offset:49152
  s_mov_b32 m0, 139264
  v_mfma_f32_16x16x32_bf16 v[168:171], v[36:39], v[100:103], v[168:171]
  ds_read_b128 v[20:23], v1 offset:49664
  buffer_load_dword v7, s[4:7], 0 offen lds
  v_mfma_f32_16x16x32_bf16 v[172:175], v[32:35], v[104:107], v[172:175]
  ds_read_b128 v[24:27], v1 offset:51200
  v_add_u32 v7, 0x8000, v7
  v_mfma_f32_16x16x32_bf16 v[172:175], v[36:39], v[108:111], v[172:175]
  ds_read_b128 v[28:31], v1 offset:51712
  s_waitcnt lgkmcnt(4)
  v_mfma_f32_16x16x32_bf16 v[176:179], v[40:43], v[80:83], v[176:179]
  ds_read_b128 v[32:35], v1 offset:53248
  v_cvt_pk_bf16_f32 v68, v8, v9
  v_mfma_f32_16x16x32_bf16 v[176:179], v[44:47], v[84:87], v[176:179]
  ds_read_b128 v[36:39], v1 offset:53760
  v_add_f32 v14, v14, v9
  v_mfma_f32_16x16x32_bf16 v[180:183], v[40:43], v[88:91], v[180:183]
  v_exp_f32 v10, v122
  v_mfma_f32_16x16x32_bf16 v[180:183], v[44:47], v[92:95], v[180:183]
  v_exp_f32 v11, v123
  v_mfma_f32_16x16x32_bf16 v[184:187], v[40:43], v[96:99], v[184:187]
  v_add_f32 v14, v14, v10
  v_cvt_pk_bf16_f32 v69, v10, v11
  v_mfma_f32_16x16x32_bf16 v[184:187], v[44:47], v[100:103], v[184:187]
  v_add_f32 v14, v14, v11
  v_mfma_f32_16x16x32_bf16 v[188:191], v[40:43], v[104:107], v[188:191]
  ds_read_b128 v[40:43], v1 offset:55296
  v_mfma_f32_16x16x32_bf16 v[188:191], v[44:47], v[108:111], v[188:191]
  s_waitcnt vmcnt(13) lgkmcnt(1)
  s_barrier
  v_mfma_f32_16x16x32_bf16 v[112:115], v[16:19], a[0:3], 0
  ds_read_b128 v[44:47], v1 offset:55808
  s_add_u32 m0, s25, 32768
  v_mfma_f32_16x16x32_bf16 v[112:115], v[20:23], a[4:7], v[112:115]
  buffer_load_dwordx4 v4, s[8:11], s40 offen offset:0 lds
  v_mfma_f32_16x16x32_bf16 v[112:115], v[24:27], a[8:11], v[112:115]
  v_exp_f32 v8, v124
  v_mfma_f32_16x16x32_bf16 v[112:115], v[28:31], a[12:15], v[112:115]
  v_exp_f32 v9, v125
  v_mfma_f32_16x16x32_bf16 v[112:115], v[32:35], a[16:19], v[112:115]
  v_add_f32 v15, v15, v8
  v_cvt_pk_bf16_f32 v76, v8, v9
  v_mfma_f32_16x16x32_bf16 v[112:115], v[36:39], a[20:23], v[112:115]
  v_add_f32 v15, v15, v9
  s_waitcnt lgkmcnt(0)
  v_mfma_f32_16x16x32_bf16 v[112:115], v[40:43], a[24:27], v[112:115]
  v_exp_f32 v10, v126
  v_mfma_f32_16x16x32_bf16 v[112:115], v[44:47], a[28:31], v[112:115]
  buffer_load_dwordx4 v4, s[8:11], s41 offen offset:1024 lds
  v_mfma_f32_16x16x32_bf16 v[116:119], v[16:19], a[32:35], 0
  v_exp_f32 v11, v127
  v_mfma_f32_16x16x32_bf16 v[116:119], v[20:23], a[36:39], v[116:119]
  v_add_f32 v15, v15, v10
  v_cvt_pk_bf16_f32 v77, v10, v11
  v_mfma_f32_16x16x32_bf16 v[116:119], v[24:27], a[40:43], v[116:119]
  v_add_f32 v15, v15, v11
  v_mfma_f32_16x16x32_bf16 v[116:119], v[28:31], a[44:47], v[116:119]
  v_mfma_f32_16x16x32_bf16 v[116:119], v[32:35], a[48:51], v[116:119]
  v_mfma_f32_16x16x32_bf16 v[116:119], v[36:39], a[52:55], v[116:119]
  buffer_load_dwordx4 v4, s[8:11], s42 offen offset:2048 lds
  v_mfma_f32_16x16x32_bf16 v[116:119], v[40:43], a[56:59], v[116:119]
  v_mfma_f32_16x16x32_bf16 v[116:119], v[44:47], a[60:63], v[116:119]
  v_exp_f32 v8, v112
  v_mfma_f32_16x16x32_bf16 v[120:123], v[16:19], a[64:67], 0
  v_exp_f32 v9, v113
  v_mfma_f32_16x16x32_bf16 v[120:123], v[20:23], a[68:71], v[120:123]
  v_add_f32 v12, v12, v8
  v_cvt_pk_bf16_f32 v54, v8, v9
  v_mfma_f32_16x16x32_bf16 v[120:123], v[24:27], a[72:75], v[120:123]
  v_add_f32 v12, v12, v9
  v_mfma_f32_16x16x32_bf16 v[120:123], v[28:31], a[76:79], v[120:123]
  buffer_load_dwordx4 v4, s[8:11], s43 offen offset:3072 lds
  v_mfma_f32_16x16x32_bf16 v[120:123], v[32:35], a[80:83], v[120:123]
  v_exp_f32 v10, v114
  v_mfma_f32_16x16x32_bf16 v[120:123], v[36:39], a[84:87], v[120:123]
  v_exp_f32 v11, v115
  v_mfma_f32_16x16x32_bf16 v[120:123], v[40:43], a[88:91], v[120:123]
  v_add_f32 v12, v12, v10
  v_cvt_pk_bf16_f32 v55, v10, v11
  v_mfma_f32_16x16x32_bf16 v[120:123], v[44:47], a[92:95], v[120:123]
  v_add_f32 v12, v12, v11
  v_mfma_f32_16x16x32_bf16 v[124:127], v[16:19], a[96:99], 0
  ds_read_b64_tr_b16 v[16:17], v2 offset:57344
  ds_read_b64_tr_b16 v[18:19], v2 offset:59392
  v_mfma_f32_16x16x32_bf16 v[124:127], v[20:23], a[100:103], v[124:127]
  ds_read_b64_tr_b16 v[20:21], v2 offset:61440
  ds_read_b64_tr_b16 v[22:23], v2 offset:63488
  v_mfma_f32_16x16x32_bf16 v[124:127], v[24:27], a[104:107], v[124:127]
  v_mfma_f32_16x16x32_bf16 v[124:127], v[28:31], a[108:111], v[124:127]
  v_mfma_f32_16x16x32_bf16 v[124:127], v[32:35], a[112:115], v[124:127]
  v_mfma_f32_16x16x32_bf16 v[124:127], v[36:39], a[116:119], v[124:127]
  v_exp_f32 v8, v116
  v_mfma_f32_16x16x32_bf16 v[124:127], v[40:43], a[120:123], v[124:127]
  ds_read_b64_tr_b16 v[24:25], v3 offset:57344
  ds_read_b64_tr_b16 v[26:27], v3 offset:59392
  v_mfma_f32_16x16x32_bf16 v[124:127], v[44:47], a[124:127], v[124:127]
  ds_read_b64_tr_b16 v[28:29], v3 offset:61440
  s_waitcnt lgkmcnt(3)
  v_mfma_f32_16x16x32_bf16 v[192:195], v[16:19], v[80:83], v[192:195]
  ds_read_b64_tr_b16 v[30:31], v3 offset:63488
  s_add_u32 m0, s25, 40960
  v_mfma_f32_16x16x32_bf16 v[192:195], v[20:23], v[84:87], v[192:195]
  buffer_load_dwordx4 v5, s[12:15], s56 offen offset:0 lds
  v_mfma_f32_16x16x32_bf16 v[196:199], v[16:19], v[88:91], v[196:199]
  v_exp_f32 v9, v117
  v_mfma_f32_16x16x32_bf16 v[196:199], v[20:23], v[92:95], v[196:199]
  v_add_f32 v13, v13, v8
  v_cvt_pk_bf16_f32 v62, v8, v9
  v_mfma_f32_16x16x32_bf16 v[200:203], v[16:19], v[96:99], v[200:203]
  v_add_f32 v13, v13, v9
  v_mfma_f32_16x16x32_bf16 v[200:203], v[20:23], v[100:103], v[200:203]
  v_exp_f32 v10, v118
  v_mfma_f32_16x16x32_bf16 v[204:207], v[16:19], v[104:107], v[204:207]
  ds_read_b64_tr_b16 v[32:33], v2 offset:57856
  ds_read_b64_tr_b16 v[34:35], v2 offset:59904
  v_mfma_f32_16x16x32_bf16 v[204:207], v[20:23], v[108:111], v[204:207]
  ds_read_b64_tr_b16 v[36:37], v2 offset:61952
  s_waitcnt lgkmcnt(3)
  v_mfma_f32_16x16x32_bf16 v[208:211], v[24:27], v[80:83], v[208:211]
  ds_read_b64_tr_b16 v[38:39], v2 offset:64000
  buffer_load_dwordx4 v5, s[12:15], s57 offen offset:1024 lds
  v_mfma_f32_16x16x32_bf16 v[208:211], v[28:31], v[84:87], v[208:211]
  v_exp_f32 v11, v119
  v_mfma_f32_16x16x32_bf16 v[212:215], v[24:27], v[88:91], v[212:215]
  v_add_f32 v13, v13, v10
  v_cvt_pk_bf16_f32 v63, v10, v11
  v_mfma_f32_16x16x32_bf16 v[212:215], v[28:31], v[92:95], v[212:215]
  v_add_f32 v13, v13, v11
  v_mfma_f32_16x16x32_bf16 v[216:219], v[24:27], v[96:99], v[216:219]
  v_mfma_f32_16x16x32_bf16 v[216:219], v[28:31], v[100:103], v[216:219]
  buffer_load_dwordx4 v5, s[12:15], s58 offen offset:2048 lds
  v_mfma_f32_16x16x32_bf16 v[220:223], v[24:27], v[104:107], v[220:223]
  ds_read_b64_tr_b16 v[40:41], v3 offset:57856
  ds_read_b64_tr_b16 v[42:43], v3 offset:59904
  v_mfma_f32_16x16x32_bf16 v[220:223], v[28:31], v[108:111], v[220:223]
  ds_read_b64_tr_b16 v[44:45], v3 offset:61952
  s_waitcnt lgkmcnt(3)
  v_mfma_f32_16x16x32_bf16 v[224:227], v[32:35], v[80:83], v[224:227]
  ds_read_b64_tr_b16 v[46:47], v3 offset:64000
  v_mfma_f32_16x16x32_bf16 v[224:227], v[36:39], v[84:87], v[224:227]
  v_exp_f32 v8, v120
  v_mfma_f32_16x16x32_bf16 v[228:231], v[32:35], v[88:91], v[228:231]
  v_exp_f32 v9, v121
  v_mfma_f32_16x16x32_bf16 v[228:231], v[36:39], v[92:95], v[228:231]
  buffer_load_dwordx4 v5, s[12:15], s59 offen offset:3072 lds
  v_add_f32 v14, v14, v8
  v_mfma_f32_16x16x32_bf16 v[232:235], v[32:35], v[96:99], v[232:235]
  ds_read_b128 v[16:19], v1 offset:0
  v_cvt_pk_bf16_f32 v70, v8, v9
  v_mfma_f32_16x16x32_bf16 v[232:235], v[36:39], v[100:103], v[232:235]
  ds_read_b128 v[20:23], v1 offset:512
  v_add_f32 v14, v14, v9
  v_mfma_f32_16x16x32_bf16 v[236:239], v[32:35], v[104:107], v[236:239]
  ds_read_b128 v[24:27], v1 offset:2048
  v_mfma_f32_16x16x32_bf16 v[236:239], v[36:39], v[108:111], v[236:239]
  ds_read_b128 v[28:31], v1 offset:2560
  s_waitcnt lgkmcnt(4)
  v_mfma_f32_16x16x32_bf16 v[240:243], v[40:43], v[80:83], v[240:243]
  ds_read_b128 v[32:35], v1 offset:4096
  v_mfma_f32_16x16x32_bf16 v[240:243], v[44:47], v[84:87], v[240:243]
  ds_read_b128 v[36:39], v1 offset:4608
  v_mfma_f32_16x16x32_bf16 v[244:247], v[40:43], v[88:91], v[244:247]
  v_exp_f32 v10, v122
  v_mfma_f32_16x16x32_bf16 v[244:247], v[44:47], v[92:95], v[244:247]
  v_exp_f32 v11, v123
  v_mfma_f32_16x16x32_bf16 v[248:251], v[40:43], v[96:99], v[248:251]
  v_add_f32 v14, v14, v10
  v_cvt_pk_bf16_f32 v71, v10, v11
  v_mfma_f32_16x16x32_bf16 v[248:251], v[44:47], v[100:103], v[248:251]
  v_add_f32 v14, v14, v11
  v_mfma_f32_16x16x32_bf16 v[252:255], v[40:43], v[104:107], v[252:255]
  ds_read_b128 v[40:43], v1 offset:6144
  v_mfma_f32_16x16x32_bf16 v[252:255], v[44:47], v[108:111], v[252:255]
  s_waitcnt vmcnt(13) lgkmcnt(1)
  s_barrier
  v_mfma_f32_16x16x32_bf16 v[112:115], v[16:19], a[0:3], 0
  ds_read_b128 v[44:47], v1 offset:6656
  s_add_u32 m0, s25, 49152
  v_mfma_f32_16x16x32_bf16 v[112:115], v[20:23], a[4:7], v[112:115]
  buffer_load_dwordx4 v4, s[8:11], s44 offen offset:0 lds
  v_mfma_f32_16x16x32_bf16 v[112:115], v[24:27], a[8:11], v[112:115]
  v_exp_f32 v8, v124
  v_mfma_f32_16x16x32_bf16 v[112:115], v[28:31], a[12:15], v[112:115]
  v_exp_f32 v9, v125
  v_mfma_f32_16x16x32_bf16 v[112:115], v[32:35], a[16:19], v[112:115]
  v_add_f32 v15, v15, v8
  v_cvt_pk_bf16_f32 v78, v8, v9
  v_mfma_f32_16x16x32_bf16 v[112:115], v[36:39], a[20:23], v[112:115]
  v_add_f32 v15, v15, v9
  s_waitcnt lgkmcnt(0)
  v_mfma_f32_16x16x32_bf16 v[112:115], v[40:43], a[24:27], v[112:115]
  v_exp_f32 v10, v126
  v_mfma_f32_16x16x32_bf16 v[112:115], v[44:47], a[28:31], v[112:115]
  buffer_load_dwordx4 v4, s[8:11], s45 offen offset:1024 lds
  v_mfma_f32_16x16x32_bf16 v[116:119], v[16:19], a[32:35], 0
  v_exp_f32 v11, v127
  v_mfma_f32_16x16x32_bf16 v[116:119], v[20:23], a[36:39], v[116:119]
  v_add_f32 v15, v15, v10
  v_cvt_pk_bf16_f32 v79, v10, v11
  v_mfma_f32_16x16x32_bf16 v[116:119], v[24:27], a[40:43], v[116:119]
  v_add_f32 v15, v15, v11
  v_mfma_f32_16x16x32_bf16 v[116:119], v[28:31], a[44:47], v[116:119]
  v_mfma_f32_16x16x32_bf16 v[116:119], v[32:35], a[48:51], v[116:119]
  v_mfma_f32_16x16x32_bf16 v[116:119], v[36:39], a[52:55], v[116:119]
  buffer_load_dwordx4 v4, s[8:11], s46 offen offset:2048 lds
  v_mfma_f32_16x16x32_bf16 v[116:119], v[40:43], a[56:59], v[116:119]
  v_mfma_f32_16x16x32_bf16 v[116:119], v[44:47], a[60:63], v[116:119]
  v_exp_f32 v8, v112
  v_mfma_f32_16x16x32_bf16 v[120:123], v[16:19], a[64:67], 0
  v_exp_f32 v9, v113
  v_mfma_f32_16x16x32_bf16 v[120:123], v[20:23], a[68:71], v[120:123]
  v_add_f32 v12, v12, v8
  v_cvt_pk_bf16_f32 v80, v8, v9
  v_mfma_f32_16x16x32_bf16 v[120:123], v[24:27], a[72:75], v[120:123]
  v_add_f32 v12, v12, v9
  v_mfma_f32_16x16x32_bf16 v[120:123], v[28:31], a[76:79], v[120:123]
  buffer_load_dwordx4 v4, s[8:11], s47 offen offset:3072 lds
  v_mfma_f32_16x16x32_bf16 v[120:123], v[32:35], a[80:83], v[120:123]
  v_add_u32 v4, 0x8000, v4
  v_mfma_f32_16x16x32_bf16 v[120:123], v[36:39], a[84:87], v[120:123]
  v_exp_f32 v10, v114
  v_mfma_f32_16x16x32_bf16 v[120:123], v[40:43], a[88:91], v[120:123]
  v_exp_f32 v11, v115
  v_mfma_f32_16x16x32_bf16 v[120:123], v[44:47], a[92:95], v[120:123]
  v_add_f32 v12, v12, v10
  v_cvt_pk_bf16_f32 v81, v10, v11
  v_mfma_f32_16x16x32_bf16 v[124:127], v[16:19], a[96:99], 0
  ds_read_b64_tr_b16 v[16:17], v2 offset:8192
  ds_read_b64_tr_b16 v[18:19], v2 offset:10240
  v_mfma_f32_16x16x32_bf16 v[124:127], v[20:23], a[100:103], v[124:127]
  ds_read_b64_tr_b16 v[20:21], v2 offset:12288
  ds_read_b64_tr_b16 v[22:23], v2 offset:14336
  v_mfma_f32_16x16x32_bf16 v[124:127], v[24:27], a[104:107], v[124:127]
  v_add_f32 v12, v12, v11
  v_mfma_f32_16x16x32_bf16 v[124:127], v[28:31], a[108:111], v[124:127]
  v_mfma_f32_16x16x32_bf16 v[124:127], v[32:35], a[112:115], v[124:127]
  v_mfma_f32_16x16x32_bf16 v[124:127], v[36:39], a[116:119], v[124:127]
  v_exp_f32 v8, v116
  v_mfma_f32_16x16x32_bf16 v[124:127], v[40:43], a[120:123], v[124:127]
  ds_read_b64_tr_b16 v[24:25], v3 offset:8192
  ds_read_b64_tr_b16 v[26:27], v3 offset:10240
  v_mfma_f32_16x16x32_bf16 v[124:127], v[44:47], a[124:127], v[124:127]
  ds_read_b64_tr_b16 v[28:29], v3 offset:12288
  s_waitcnt lgkmcnt(3)
  v_mfma_f32_16x16x32_bf16 a[128:131], v[16:19], v[48:51], a[128:131]
  ds_read_b64_tr_b16 v[30:31], v3 offset:14336
  s_add_u32 m0, s25, 57344
  v_mfma_f32_16x16x32_bf16 a[128:131], v[20:23], v[52:55], a[128:131]
  buffer_load_dwordx4 v5, s[12:15], s60 offen offset:0 lds
  v_mfma_f32_16x16x32_bf16 a[132:135], v[16:19], v[56:59], a[132:135]
  v_exp_f32 v9, v117
  v_mfma_f32_16x16x32_bf16 a[132:135], v[20:23], v[60:63], a[132:135]
  v_add_f32 v13, v13, v8
  v_cvt_pk_bf16_f32 v88, v8, v9
  v_mfma_f32_16x16x32_bf16 a[136:139], v[16:19], v[64:67], a[136:139]
  v_add_f32 v13, v13, v9
  v_mfma_f32_16x16x32_bf16 a[136:139], v[20:23], v[68:71], a[136:139]
  v_exp_f32 v10, v118
  v_mfma_f32_16x16x32_bf16 a[140:143], v[16:19], v[72:75], a[140:143]
  ds_read_b64_tr_b16 v[32:33], v2 offset:8704
  ds_read_b64_tr_b16 v[34:35], v2 offset:10752
  v_mfma_f32_16x16x32_bf16 a[140:143], v[20:23], v[76:79], a[140:143]
  ds_read_b64_tr_b16 v[36:37], v2 offset:12800
  s_waitcnt lgkmcnt(3)
  v_mfma_f32_16x16x32_bf16 a[144:147], v[24:27], v[48:51], a[144:147]
  ds_read_b64_tr_b16 v[38:39], v2 offset:14848
  buffer_load_dwordx4 v5, s[12:15], s61 offen offset:1024 lds
  v_mfma_f32_16x16x32_bf16 a[144:147], v[28:31], v[52:55], a[144:147]
  v_exp_f32 v11, v119
  v_mfma_f32_16x16x32_bf16 a[148:151], v[24:27], v[56:59], a[148:151]
  v_add_f32 v13, v13, v10
  v_cvt_pk_bf16_f32 v89, v10, v11
  v_mfma_f32_16x16x32_bf16 a[148:151], v[28:31], v[60:63], a[148:151]
  v_add_f32 v13, v13, v11
  v_mfma_f32_16x16x32_bf16 a[152:155], v[24:27], v[64:67], a[152:155]
  v_mfma_f32_16x16x32_bf16 a[152:155], v[28:31], v[68:71], a[152:155]
  buffer_load_dwordx4 v5, s[12:15], s62 offen offset:2048 lds
  v_mfma_f32_16x16x32_bf16 a[156:159], v[24:27], v[72:75], a[156:159]
  ds_read_b64_tr_b16 v[40:41], v3 offset:8704
  ds_read_b64_tr_b16 v[42:43], v3 offset:10752
  v_mfma_f32_16x16x32_bf16 a[156:159], v[28:31], v[76:79], a[156:159]
  ds_read_b64_tr_b16 v[44:45], v3 offset:12800
  s_waitcnt lgkmcnt(3)
  v_mfma_f32_16x16x32_bf16 a[160:163], v[32:35], v[48:51], a[160:163]
  ds_read_b64_tr_b16 v[46:47], v3 offset:14848
  v_mfma_f32_16x16x32_bf16 a[160:163], v[36:39], v[52:55], a[160:163]
  v_exp_f32 v8, v120
  v_mfma_f32_16x16x32_bf16 a[164:167], v[32:35], v[56:59], a[164:167]
  v_exp_f32 v9, v121
  v_mfma_f32_16x16x32_bf16 a[164:167], v[36:39], v[60:63], a[164:167]
  buffer_load_dwordx4 v5, s[12:15], s63 offen offset:3072 lds
  v_add_f32 v14, v14, v8
  v_mfma_f32_16x16x32_bf16 a[168:171], v[32:35], v[64:67], a[168:171]
  ds_read_b128 v[16:19], v1 offset:16384
  v_add_u32 v5, 0x8000, v5
  v_mfma_f32_16x16x32_bf16 a[168:171], v[36:39], v[68:71], a[168:171]
  ds_read_b128 v[20:23], v1 offset:16896
  v_cvt_pk_bf16_f32 v96, v8, v9
  v_mfma_f32_16x16x32_bf16 a[172:175], v[32:35], v[72:75], a[172:175]
  ds_read_b128 v[24:27], v1 offset:18432
  v_add_f32 v14, v14, v9
  v_mfma_f32_16x16x32_bf16 a[172:175], v[36:39], v[76:79], a[172:175]
  ds_read_b128 v[28:31], v1 offset:18944
  s_waitcnt lgkmcnt(4)
  v_mfma_f32_16x16x32_bf16 a[176:179], v[40:43], v[48:51], a[176:179]
  ds_read_b128 v[32:35], v1 offset:20480
  v_mfma_f32_16x16x32_bf16 a[176:179], v[44:47], v[52:55], a[176:179]
  ds_read_b128 v[36:39], v1 offset:20992
  v_mfma_f32_16x16x32_bf16 a[180:183], v[40:43], v[56:59], a[180:183]
  v_exp_f32 v10, v122
  v_mfma_f32_16x16x32_bf16 a[180:183], v[44:47], v[60:63], a[180:183]
  v_exp_f32 v11, v123
  v_mfma_f32_16x16x32_bf16 a[184:187], v[40:43], v[64:67], a[184:187]
  v_add_f32 v14, v14, v10
  v_cvt_pk_bf16_f32 v97, v10, v11
  v_mfma_f32_16x16x32_bf16 a[184:187], v[44:47], v[68:71], a[184:187]
  v_add_f32 v14, v14, v11
  v_mfma_f32_16x16x32_bf16 a[188:191], v[40:43], v[72:75], a[188:191]
  ds_read_b128 v[40:43], v1 offset:22528
  v_mfma_f32_16x16x32_bf16 a[188:191], v[44:47], v[76:79], a[188:191]
  s_waitcnt vmcnt(12) lgkmcnt(1)
  s_barrier
  v_mfma_f32_16x16x32_bf16 v[112:115], v[16:19], a[0:3], 0
  ds_read_b128 v[44:47], v1 offset:23040
  s_cmp_eq_u32 s26, 1
  s_cselect_b32 s10, 0, s10
  s_add_u32 m0, s25, 0
  v_mfma_f32_16x16x32_bf16 v[112:115], v[20:23], a[4:7], v[112:115]
  buffer_load_dwordx4 v4, s[8:11], s32 offen offset:0 lds
  v_mfma_f32_16x16x32_bf16 v[112:115], v[24:27], a[8:11], v[112:115]
  v_exp_f32 v8, v124
  v_mfma_f32_16x16x32_bf16 v[112:115], v[28:31], a[12:15], v[112:115]
  v_exp_f32 v9, v125
  v_mfma_f32_16x16x32_bf16 v[112:115], v[32:35], a[16:19], v[112:115]
  v_add_f32 v15, v15, v8
  v_cvt_pk_bf16_f32 v104, v8, v9
  v_mfma_f32_16x16x32_bf16 v[112:115], v[36:39], a[20:23], v[112:115]
  v_add_f32 v15, v15, v9
  s_waitcnt lgkmcnt(0)
  v_mfma_f32_16x16x32_bf16 v[112:115], v[40:43], a[24:27], v[112:115]
  v_exp_f32 v10, v126
  v_mfma_f32_16x16x32_bf16 v[112:115], v[44:47], a[28:31], v[112:115]
  buffer_load_dwordx4 v4, s[8:11], s33 offen offset:1024 lds
  v_mfma_f32_16x16x32_bf16 v[116:119], v[16:19], a[32:35], 0
  v_exp_f32 v11, v127
  v_mfma_f32_16x16x32_bf16 v[116:119], v[20:23], a[36:39], v[116:119]
  v_add_f32 v15, v15, v10
  v_cvt_pk_bf16_f32 v105, v10, v11
  v_mfma_f32_16x16x32_bf16 v[116:119], v[24:27], a[40:43], v[116:119]
  v_add_f32 v15, v15, v11
  v_mfma_f32_16x16x32_bf16 v[116:119], v[28:31], a[44:47], v[116:119]
  v_mfma_f32_16x16x32_bf16 v[116:119], v[32:35], a[48:51], v[116:119]
  v_mfma_f32_16x16x32_bf16 v[116:119], v[36:39], a[52:55], v[116:119]
  buffer_load_dwordx4 v4, s[8:11], s34 offen offset:2048 lds
  v_mfma_f32_16x16x32_bf16 v[116:119], v[40:43], a[56:59], v[116:119]
  v_mfma_f32_16x16x32_bf16 v[116:119], v[44:47], a[60:63], v[116:119]
  v_exp_f32 v8, v112
  v_mfma_f32_16x16x32_bf16 v[120:123], v[16:19], a[64:67], 0
  v_exp_f32 v9, v113
  v_mfma_f32_16x16x32_bf16 v[120:123], v[20:23], a[68:71], v[120:123]
  v_add_f32 v12, v12, v8
  v_cvt_pk_bf16_f32 v82, v8, v9
  v_mfma_f32_16x16x32_bf16 v[120:123], v[24:27], a[72:75], v[120:123]
  v_add_f32 v12, v12, v9
  v_mfma_f32_16x16x32_bf16 v[120:123], v[28:31], a[76:79], v[120:123]
  buffer_load_dwordx4 v4, s[8:11], s35 offen offset:3072 lds
  v_mfma_f32_16x16x32_bf16 v[120:123], v[32:35], a[80:83], v[120:123]
  v_exp_f32 v10, v114
  v_mfma_f32_16x16x32_bf16 v[120:123], v[36:39], a[84:87], v[120:123]
  v_exp_f32 v11, v115
  v_mfma_f32_16x16x32_bf16 v[120:123], v[40:43], a[88:91], v[120:123]
  v_add_f32 v12, v12, v10
  v_cvt_pk_bf16_f32 v83, v10, v11
  v_mfma_f32_16x16x32_bf16 v[120:123], v[44:47], a[92:95], v[120:123]
  v_add_f32 v12, v12, v11
  v_mfma_f32_16x16x32_bf16 v[124:127], v[16:19], a[96:99], 0
  ds_read_b64_tr_b16 v[16:17], v2 offset:24576
  ds_read_b64_tr_b16 v[18:19], v2 offset:26624
  v_mfma_f32_16x16x32_bf16 v[124:127], v[20:23], a[100:103], v[124:127]
  ds_read_b64_tr_b16 v[20:21], v2 offset:28672
  ds_read_b64_tr_b16 v[22:23], v2 offset:30720
  v_mfma_f32_16x16x32_bf16 v[124:127], v[24:27], a[104:107], v[124:127]
  v_mfma_f32_16x16x32_bf16 v[124:127], v[28:31], a[108:111], v[124:127]
  v_mfma_f32_16x16x32_bf16 v[124:127], v[32:35], a[112:115], v[124:127]
  v_mfma_f32_16x16x32_bf16 v[124:127], v[36:39], a[116:119], v[124:127]
  v_exp_f32 v8, v116
  v_mfma_f32_16x16x32_bf16 v[124:127], v[40:43], a[120:123], v[124:127]
  ds_read_b64_tr_b16 v[24:25], v3 offset:24576
  ds_read_b64_tr_b16 v[26:27], v3 offset:26624
  v_mfma_f32_16x16x32_bf16 v[124:127], v[44:47], a[124:127], v[124:127]
  ds_read_b64_tr_b16 v[28:29], v3 offset:28672
  s_waitcnt lgkmcnt(3)
  v_mfma_f32_16x16x32_bf16 a[192:195], v[16:19], v[48:51], a[192:195]
  ds_read_b64_tr_b16 v[30:31], v3 offset:30720
  s_add_u32 m0, s25, 8192
  v_mfma_f32_16x16x32_bf16 a[192:195], v[20:23], v[52:55], a[192:195]
  buffer_load_dwordx4 v5, s[12:15], s48 offen offset:0 lds
  v_mfma_f32_16x16x32_bf16 a[196:199], v[16:19], v[56:59], a[196:199]
  v_exp_f32 v9, v117
  v_mfma_f32_16x16x32_bf16 a[196:199], v[20:23], v[60:63], a[196:199]
  v_add_f32 v13, v13, v8
  v_cvt_pk_bf16_f32 v90, v8, v9
  v_mfma_f32_16x16x32_bf16 a[200:203], v[16:19], v[64:67], a[200:203]
  v_add_f32 v13, v13, v9
  v_mfma_f32_16x16x32_bf16 a[200:203], v[20:23], v[68:71], a[200:203]
  v_exp_f32 v10, v118
  v_mfma_f32_16x16x32_bf16 a[204:207], v[16:19], v[72:75], a[204:207]
  ds_read_b64_tr_b16 v[32:33], v2 offset:25088
  ds_read_b64_tr_b16 v[34:35], v2 offset:27136
  v_mfma_f32_16x16x32_bf16 a[204:207], v[20:23], v[76:79], a[204:207]
  ds_read_b64_tr_b16 v[36:37], v2 offset:29184
  s_waitcnt lgkmcnt(3)
  v_mfma_f32_16x16x32_bf16 a[208:211], v[24:27], v[48:51], a[208:211]
  ds_read_b64_tr_b16 v[38:39], v2 offset:31232
  buffer_load_dwordx4 v5, s[12:15], s49 offen offset:1024 lds
  v_mfma_f32_16x16x32_bf16 a[208:211], v[28:31], v[52:55], a[208:211]
  v_exp_f32 v11, v119
  v_mfma_f32_16x16x32_bf16 a[212:215], v[24:27], v[56:59], a[212:215]
  v_add_f32 v13, v13, v10
  v_cvt_pk_bf16_f32 v91, v10, v11
  v_mfma_f32_16x16x32_bf16 a[212:215], v[28:31], v[60:63], a[212:215]
  v_add_f32 v13, v13, v11
  v_mfma_f32_16x16x32_bf16 a[216:219], v[24:27], v[64:67], a[216:219]
  v_mfma_f32_16x16x32_bf16 a[216:219], v[28:31], v[68:71], a[216:219]
  buffer_load_dwordx4 v5, s[12:15], s50 offen offset:2048 lds
  v_mfma_f32_16x16x32_bf16 a[220:223], v[24:27], v[72:75], a[220:223]
  ds_read_b64_tr_b16 v[40:41], v3 offset:25088
  ds_read_b64_tr_b16 v[42:43], v3 offset:27136
  v_mfma_f32_16x16x32_bf16 a[220:223], v[28:31], v[76:79], a[220:223]
  ds_read_b64_tr_b16 v[44:45], v3 offset:29184
  s_waitcnt lgkmcnt(3)
  v_mfma_f32_16x16x32_bf16 a[224:227], v[32:35], v[48:51], a[224:227]
  ds_read_b64_tr_b16 v[46:47], v3 offset:31232
  v_mfma_f32_16x16x32_bf16 a[224:227], v[36:39], v[52:55], a[224:227]
  v_exp_f32 v8, v120
  v_mfma_f32_16x16x32_bf16 a[228:231], v[32:35], v[56:59], a[228:231]
  v_exp_f32 v9, v121
  v_mfma_f32_16x16x32_bf16 a[228:231], v[36:39], v[60:63], a[228:231]
  buffer_load_dwordx4 v5, s[12:15], s51 offen offset:3072 lds
  v_add_f32 v14, v14, v8
  v_mfma_f32_16x16x32_bf16 a[232:235], v[32:35], v[64:67], a[232:235]
  ds_read_b128 v[16:19], v1 offset:32768
  v_cvt_pk_bf16_f32 v98, v8, v9
  v_mfma_f32_16x16x32_bf16 a[232:235], v[36:39], v[68:71], a[232:235]
  ds_read_b128 v[20:23], v1 offset:33280
  v_add_f32 v14, v14, v9
  v_mfma_f32_16x16x32_bf16 a[236:239], v[32:35], v[72:75], a[236:239]
  ds_read_b128 v[24:27], v1 offset:34816
  v_mfma_f32_16x16x32_bf16 a[236:239], v[36:39], v[76:79], a[236:239]
  ds_read_b128 v[28:31], v1 offset:35328
  s_waitcnt lgkmcnt(4)
  v_mfma_f32_16x16x32_bf16 a[240:243], v[40:43], v[48:51], a[240:243]
  ds_read_b128 v[32:35], v1 offset:36864
  v_mfma_f32_16x16x32_bf16 a[240:243], v[44:47], v[52:55], a[240:243]
  ds_read_b128 v[36:39], v1 offset:37376
  v_mfma_f32_16x16x32_bf16 a[244:247], v[40:43], v[56:59], a[244:247]
  v_exp_f32 v10, v122
  v_mfma_f32_16x16x32_bf16 a[244:247], v[44:47], v[60:63], a[244:247]
  v_exp_f32 v11, v123
  v_mfma_f32_16x16x32_bf16 a[248:251], v[40:43], v[64:67], a[248:251]
  v_add_f32 v14, v14, v10
  v_cvt_pk_bf16_f32 v99, v10, v11
  v_mfma_f32_16x16x32_bf16 a[248:251], v[44:47], v[68:71], a[248:251]
  v_add_f32 v14, v14, v11
  v_mfma_f32_16x16x32_bf16 a[252:255], v[40:43], v[72:75], a[252:255]
  ds_read_b128 v[40:43], v1 offset:38912
  v_mfma_f32_16x16x32_bf16 a[252:255], v[44:47], v[76:79], a[252:255]
  s_waitcnt vmcnt(12) lgkmcnt(1)
  s_barrier
  v_mfma_f32_16x16x32_bf16 v[112:115], v[16:19], a[0:3], 0
  ds_read_b128 v[44:47], v1 offset:39424
  s_add_u32 m0, s25, 16384
  v_mfma_f32_16x16x32_bf16 v[112:115], v[20:23], a[4:7], v[112:115]
  buffer_load_dwordx4 v4, s[8:11], s36 offen offset:0 lds
  v_mfma_f32_16x16x32_bf16 v[112:115], v[24:27], a[8:11], v[112:115]
  v_exp_f32 v8, v124
  v_mfma_f32_16x16x32_bf16 v[112:115], v[28:31], a[12:15], v[112:115]
  v_exp_f32 v9, v125
  v_mfma_f32_16x16x32_bf16 v[112:115], v[32:35], a[16:19], v[112:115]
  v_add_f32 v15, v15, v8
  v_cvt_pk_bf16_f32 v106, v8, v9
  v_mfma_f32_16x16x32_bf16 v[112:115], v[36:39], a[20:23], v[112:115]
  v_add_f32 v15, v15, v9
  s_waitcnt lgkmcnt(0)
  v_mfma_f32_16x16x32_bf16 v[112:115], v[40:43], a[24:27], v[112:115]
  v_exp_f32 v10, v126
  v_mfma_f32_16x16x32_bf16 v[112:115], v[44:47], a[28:31], v[112:115]
  buffer_load_dwordx4 v4, s[8:11], s37 offen offset:1024 lds
  v_mfma_f32_16x16x32_bf16 v[116:119], v[16:19], a[32:35], 0
  v_exp_f32 v11, v127
  v_mfma_f32_16x16x32_bf16 v[116:119], v[20:23], a[36:39], v[116:119]
  v_add_f32 v15, v15, v10
  v_cvt_pk_bf16_f32 v107, v10, v11
  v_mfma_f32_16x16x32_bf16 v[116:119], v[24:27], a[40:43], v[116:119]
  v_add_f32 v15, v15, v11
  v_mfma_f32_16x16x32_bf16 v[116:119], v[28:31], a[44:47], v[116:119]
  v_mfma_f32_16x16x32_bf16 v[116:119], v[32:35], a[48:51], v[116:119]
  v_mfma_f32_16x16x32_bf16 v[116:119], v[36:39], a[52:55], v[116:119]
  buffer_load_dwordx4 v4, s[8:11], s38 offen offset:2048 lds
  v_mfma_f32_16x16x32_bf16 v[116:119], v[40:43], a[56:59], v[116:119]
  v_mfma_f32_16x16x32_bf16 v[116:119], v[44:47], a[60:63], v[116:119]
  v_exp_f32 v8, v112
  v_mfma_f32_16x16x32_bf16 v[120:123], v[16:19], a[64:67], 0
  v_exp_f32 v9, v113
  v_mfma_f32_16x16x32_bf16 v[120:123], v[20:23], a[68:71], v[120:123]
  v_add_f32 v12, v12, v8
  v_cvt_pk_bf16_f32 v84, v8, v9
  v_mfma_f32_16x16x32_bf16 v[120:123], v[24:27], a[72:75], v[120:123]
  v_add_f32 v12, v12, v9
  v_mfma_f32_16x16x32_bf16 v[120:123], v[28:31], a[76:79], v[120:123]
  buffer_load_dwordx4 v4, s[8:11], s39 offen offset:3072 lds
  v_mfma_f32_16x16x32_bf16 v[120:123], v[32:35], a[80:83], v[120:123]
  v_exp_f32 v10, v114
  v_mfma_f32_16x16x32_bf16 v[120:123], v[36:39], a[84:87], v[120:123]
  v_exp_f32 v11, v115
  v_mfma_f32_16x16x32_bf16 v[120:123], v[40:43], a[88:91], v[120:123]
  v_add_f32 v12, v12, v10
  v_cvt_pk_bf16_f32 v85, v10, v11
  v_mfma_f32_16x16x32_bf16 v[120:123], v[44:47], a[92:95], v[120:123]
  v_add_f32 v12, v12, v11
  v_mfma_f32_16x16x32_bf16 v[124:127], v[16:19], a[96:99], 0
  ds_read_b64_tr_b16 v[16:17], v2 offset:40960
  ds_read_b64_tr_b16 v[18:19], v2 offset:43008
  v_mfma_f32_16x16x32_bf16 v[124:127], v[20:23], a[100:103], v[124:127]
  ds_read_b64_tr_b16 v[20:21], v2 offset:45056
  ds_read_b64_tr_b16 v[22:23], v2 offset:47104
  v_mfma_f32_16x16x32_bf16 v[124:127], v[24:27], a[104:107], v[124:127]
  v_mfma_f32_16x16x32_bf16 v[124:127], v[28:31], a[108:111], v[124:127]
  v_mfma_f32_16x16x32_bf16 v[124:127], v[32:35], a[112:115], v[124:127]
  v_mfma_f32_16x16x32_bf16 v[124:127], v[36:39], a[116:119], v[124:127]
  v_exp_f32 v8, v116
  v_mfma_f32_16x16x32_bf16 v[124:127], v[40:43], a[120:123], v[124:127]
  ds_read_b64_tr_b16 v[24:25], v3 offset:40960
  ds_read_b64_tr_b16 v[26:27], v3 offset:43008
  v_mfma_f32_16x16x32_bf16 v[124:127], v[44:47], a[124:127], v[124:127]
  ds_read_b64_tr_b16 v[28:29], v3 offset:45056
  s_waitcnt lgkmcnt(3)
  v_mfma_f32_16x16x32_bf16 v[128:131], v[16:19], v[48:51], v[128:131]
  ds_read_b64_tr_b16 v[30:31], v3 offset:47104
  s_add_u32 m0, s25, 24576
  v_mfma_f32_16x16x32_bf16 v[128:131], v[20:23], v[52:55], v[128:131]
  buffer_load_dwordx4 v5, s[12:15], s52 offen offset:0 lds
  v_mfma_f32_16x16x32_bf16 v[132:135], v[16:19], v[56:59], v[132:135]
  v_exp_f32 v9, v117
  v_mfma_f32_16x16x32_bf16 v[132:135], v[20:23], v[60:63], v[132:135]
  v_add_f32 v13, v13, v8
  v_cvt_pk_bf16_f32 v92, v8, v9
  v_mfma_f32_16x16x32_bf16 v[136:139], v[16:19], v[64:67], v[136:139]
  v_add_f32 v13, v13, v9
  v_mfma_f32_16x16x32_bf16 v[136:139], v[20:23], v[68:71], v[136:139]
  v_exp_f32 v10, v118
  v_mfma_f32_16x16x32_bf16 v[140:143], v[16:19], v[72:75], v[140:143]
  ds_read_b64_tr_b16 v[32:33], v2 offset:41472
  ds_read_b64_tr_b16 v[34:35], v2 offset:43520
  v_mfma_f32_16x16x32_bf16 v[140:143], v[20:23], v[76:79], v[140:143]
  ds_read_b64_tr_b16 v[36:37], v2 offset:45568
  s_waitcnt lgkmcnt(3)
  v_mfma_f32_16x16x32_bf16 v[144:147], v[24:27], v[48:51], v[144:147]
  ds_read_b64_tr_b16 v[38:39], v2 offset:47616
  buffer_load_dwordx4 v5, s[12:15], s53 offen offset:1024 lds
  v_mfma_f32_16x16x32_bf16 v[144:147], v[28:31], v[52:55], v[144:147]
  v_exp_f32 v11, v119
  v_mfma_f32_16x16x32_bf16 v[148:151], v[24:27], v[56:59], v[148:151]
  v_add_f32 v13, v13, v10
  v_cvt_pk_bf16_f32 v93, v10, v11
  v_mfma_f32_16x16x32_bf16 v[148:151], v[28:31], v[60:63], v[148:151]
  v_add_f32 v13, v13, v11
  v_mfma_f32_16x16x32_bf16 v[152:155], v[24:27], v[64:67], v[152:155]
  v_mfma_f32_16x16x32_bf16 v[152:155], v[28:31], v[68:71], v[152:155]
  buffer_load_dwordx4 v5, s[12:15], s54 offen offset:2048 lds
  v_mfma_f32_16x16x32_bf16 v[156:159], v[24:27], v[72:75], v[156:159]
  ds_read_b64_tr_b16 v[40:41], v3 offset:41472
  ds_read_b64_tr_b16 v[42:43], v3 offset:43520
  v_mfma_f32_16x16x32_bf16 v[156:159], v[28:31], v[76:79], v[156:159]
  ds_read_b64_tr_b16 v[44:45], v3 offset:45568
  s_waitcnt lgkmcnt(3)
  v_mfma_f32_16x16x32_bf16 v[160:163], v[32:35], v[48:51], v[160:163]
  ds_read_b64_tr_b16 v[46:47], v3 offset:47616
  v_mfma_f32_16x16x32_bf16 v[160:163], v[36:39], v[52:55], v[160:163]
  v_exp_f32 v8, v120
  v_mfma_f32_16x16x32_bf16 v[164:167], v[32:35], v[56:59], v[164:167]
  v_exp_f32 v9, v121
  v_mfma_f32_16x16x32_bf16 v[164:167], v[36:39], v[60:63], v[164:167]
  buffer_load_dwordx4 v5, s[12:15], s55 offen offset:3072 lds
  v_add_f32 v14, v14, v8
  v_mfma_f32_16x16x32_bf16 v[168:171], v[32:35], v[64:67], v[168:171]
  ds_read_b128 v[16:19], v1 offset:49152
  s_mov_b32 m0, 139264
  v_mfma_f32_16x16x32_bf16 v[168:171], v[36:39], v[68:71], v[168:171]
  ds_read_b128 v[20:23], v1 offset:49664
  buffer_load_dword v7, s[4:7], 0 offen lds
  v_mfma_f32_16x16x32_bf16 v[172:175], v[32:35], v[72:75], v[172:175]
  ds_read_b128 v[24:27], v1 offset:51200
  v_add_u32 v7, 0x8000, v7
  v_mfma_f32_16x16x32_bf16 v[172:175], v[36:39], v[76:79], v[172:175]
  ds_read_b128 v[28:31], v1 offset:51712
  s_waitcnt lgkmcnt(4)
  v_mfma_f32_16x16x32_bf16 v[176:179], v[40:43], v[48:51], v[176:179]
  ds_read_b128 v[32:35], v1 offset:53248
  v_cvt_pk_bf16_f32 v100, v8, v9
  v_mfma_f32_16x16x32_bf16 v[176:179], v[44:47], v[52:55], v[176:179]
  ds_read_b128 v[36:39], v1 offset:53760
  v_add_f32 v14, v14, v9
  v_mfma_f32_16x16x32_bf16 v[180:183], v[40:43], v[56:59], v[180:183]
  v_exp_f32 v10, v122
  v_mfma_f32_16x16x32_bf16 v[180:183], v[44:47], v[60:63], v[180:183]
  v_exp_f32 v11, v123
  v_mfma_f32_16x16x32_bf16 v[184:187], v[40:43], v[64:67], v[184:187]
  v_add_f32 v14, v14, v10
  v_cvt_pk_bf16_f32 v101, v10, v11
  v_mfma_f32_16x16x32_bf16 v[184:187], v[44:47], v[68:71], v[184:187]
  v_add_f32 v14, v14, v11
  v_mfma_f32_16x16x32_bf16 v[188:191], v[40:43], v[72:75], v[188:191]
  ds_read_b128 v[40:43], v1 offset:55296
  v_mfma_f32_16x16x32_bf16 v[188:191], v[44:47], v[76:79], v[188:191]
  s_waitcnt vmcnt(13) lgkmcnt(1)
  s_barrier
  v_mfma_f32_16x16x32_bf16 v[112:115], v[16:19], a[0:3], 0
  ds_read_b128 v[44:47], v1 offset:55808
  s_add_u32 m0, s25, 32768
  v_mfma_f32_16x16x32_bf16 v[112:115], v[20:23], a[4:7], v[112:115]
  buffer_load_dwordx4 v4, s[8:11], s40 offen offset:0 lds
  v_mfma_f32_16x16x32_bf16 v[112:115], v[24:27], a[8:11], v[112:115]
  v_exp_f32 v8, v124
  v_mfma_f32_16x16x32_bf16 v[112:115], v[28:31], a[12:15], v[112:115]
  v_exp_f32 v9, v125
  v_mfma_f32_16x16x32_bf16 v[112:115], v[32:35], a[16:19], v[112:115]
  v_add_f32 v15, v15, v8
  v_cvt_pk_bf16_f32 v108, v8, v9
  v_mfma_f32_16x16x32_bf16 v[112:115], v[36:39], a[20:23], v[112:115]
  v_add_f32 v15, v15, v9
  s_waitcnt lgkmcnt(0)
  v_mfma_f32_16x16x32_bf16 v[112:115], v[40:43], a[24:27], v[112:115]
  v_exp_f32 v10, v126
  v_mfma_f32_16x16x32_bf16 v[112:115], v[44:47], a[28:31], v[112:115]
  buffer_load_dwordx4 v4, s[8:11], s41 offen offset:1024 lds
  v_mfma_f32_16x16x32_bf16 v[116:119], v[16:19], a[32:35], 0
  v_exp_f32 v11, v127
  v_mfma_f32_16x16x32_bf16 v[116:119], v[20:23], a[36:39], v[116:119]
  v_add_f32 v15, v15, v10
  v_cvt_pk_bf16_f32 v109, v10, v11
  v_mfma_f32_16x16x32_bf16 v[116:119], v[24:27], a[40:43], v[116:119]
  v_add_f32 v15, v15, v11
  v_mfma_f32_16x16x32_bf16 v[116:119], v[28:31], a[44:47], v[116:119]
  v_mfma_f32_16x16x32_bf16 v[116:119], v[32:35], a[48:51], v[116:119]
  v_mfma_f32_16x16x32_bf16 v[116:119], v[36:39], a[52:55], v[116:119]
  buffer_load_dwordx4 v4, s[8:11], s42 offen offset:2048 lds
  v_mfma_f32_16x16x32_bf16 v[116:119], v[40:43], a[56:59], v[116:119]
  v_mfma_f32_16x16x32_bf16 v[116:119], v[44:47], a[60:63], v[116:119]
  v_exp_f32 v8, v112
  v_mfma_f32_16x16x32_bf16 v[120:123], v[16:19], a[64:67], 0
  v_exp_f32 v9, v113
  v_mfma_f32_16x16x32_bf16 v[120:123], v[20:23], a[68:71], v[120:123]
  v_add_f32 v12, v12, v8
  v_cvt_pk_bf16_f32 v86, v8, v9
  v_mfma_f32_16x16x32_bf16 v[120:123], v[24:27], a[72:75], v[120:123]
  v_add_f32 v12, v12, v9
  v_mfma_f32_16x16x32_bf16 v[120:123], v[28:31], a[76:79], v[120:123]
  buffer_load_dwordx4 v4, s[8:11], s43 offen offset:3072 lds
  v_mfma_f32_16x16x32_bf16 v[120:123], v[32:35], a[80:83], v[120:123]
  v_exp_f32 v10, v114
  v_mfma_f32_16x16x32_bf16 v[120:123], v[36:39], a[84:87], v[120:123]
  v_exp_f32 v11, v115
  v_mfma_f32_16x16x32_bf16 v[120:123], v[40:43], a[88:91], v[120:123]
  v_add_f32 v12, v12, v10
  v_cvt_pk_bf16_f32 v87, v10, v11
  v_mfma_f32_16x16x32_bf16 v[120:123], v[44:47], a[92:95], v[120:123]
  v_add_f32 v12, v12, v11
  v_mfma_f32_16x16x32_bf16 v[124:127], v[16:19], a[96:99], 0
  ds_read_b64_tr_b16 v[16:17], v2 offset:57344
  ds_read_b64_tr_b16 v[18:19], v2 offset:59392
  v_mfma_f32_16x16x32_bf16 v[124:127], v[20:23], a[100:103], v[124:127]
  ds_read_b64_tr_b16 v[20:21], v2 offset:61440
  ds_read_b64_tr_b16 v[22:23], v2 offset:63488
  v_mfma_f32_16x16x32_bf16 v[124:127], v[24:27], a[104:107], v[124:127]
  v_mfma_f32_16x16x32_bf16 v[124:127], v[28:31], a[108:111], v[124:127]
  v_mfma_f32_16x16x32_bf16 v[124:127], v[32:35], a[112:115], v[124:127]
  v_mfma_f32_16x16x32_bf16 v[124:127], v[36:39], a[116:119], v[124:127]
  v_exp_f32 v8, v116
  v_mfma_f32_16x16x32_bf16 v[124:127], v[40:43], a[120:123], v[124:127]
  ds_read_b64_tr_b16 v[24:25], v3 offset:57344
  ds_read_b64_tr_b16 v[26:27], v3 offset:59392
  v_mfma_f32_16x16x32_bf16 v[124:127], v[44:47], a[124:127], v[124:127]
  ds_read_b64_tr_b16 v[28:29], v3 offset:61440
  s_waitcnt lgkmcnt(3)
  v_mfma_f32_16x16x32_bf16 v[192:195], v[16:19], v[48:51], v[192:195]
  ds_read_b64_tr_b16 v[30:31], v3 offset:63488
  s_add_u32 m0, s25, 40960
  v_mfma_f32_16x16x32_bf16 v[192:195], v[20:23], v[52:55], v[192:195]
  buffer_load_dwordx4 v5, s[12:15], s56 offen offset:0 lds
  v_mfma_f32_16x16x32_bf16 v[196:199], v[16:19], v[56:59], v[196:199]
  v_exp_f32 v9, v117
  v_mfma_f32_16x16x32_bf16 v[196:199], v[20:23], v[60:63], v[196:199]
  v_add_f32 v13, v13, v8
  v_cvt_pk_bf16_f32 v94, v8, v9
  v_mfma_f32_16x16x32_bf16 v[200:203], v[16:19], v[64:67], v[200:203]
  v_add_f32 v13, v13, v9
  v_mfma_f32_16x16x32_bf16 v[200:203], v[20:23], v[68:71], v[200:203]
  v_exp_f32 v10, v118
  v_mfma_f32_16x16x32_bf16 v[204:207], v[16:19], v[72:75], v[204:207]
  ds_read_b64_tr_b16 v[32:33], v2 offset:57856
  ds_read_b64_tr_b16 v[34:35], v2 offset:59904
  v_mfma_f32_16x16x32_bf16 v[204:207], v[20:23], v[76:79], v[204:207]
  ds_read_b64_tr_b16 v[36:37], v2 offset:61952
  s_waitcnt lgkmcnt(3)
  v_mfma_f32_16x16x32_bf16 v[208:211], v[24:27], v[48:51], v[208:211]
  ds_read_b64_tr_b16 v[38:39], v2 offset:64000
  buffer_load_dwordx4 v5, s[12:15], s57 offen offset:1024 lds
  v_mfma_f32_16x16x32_bf16 v[208:211], v[28:31], v[52:55], v[208:211]
  v_exp_f32 v11, v119
  v_mfma_f32_16x16x32_bf16 v[212:215], v[24:27], v[56:59], v[212:215]
  v_add_f32 v13, v13, v10
  v_cvt_pk_bf16_f32 v95, v10, v11
  v_mfma_f32_16x16x32_bf16 v[212:215], v[28:31], v[60:63], v[212:215]
  v_add_f32 v13, v13, v11
  v_mfma_f32_16x16x32_bf16 v[216:219], v[24:27], v[64:67], v[216:219]
  v_mfma_f32_16x16x32_bf16 v[216:219], v[28:31], v[68:71], v[216:219]
  buffer_load_dwordx4 v5, s[12:15], s58 offen offset:2048 lds
  v_mfma_f32_16x16x32_bf16 v[220:223], v[24:27], v[72:75], v[220:223]
  ds_read_b64_tr_b16 v[40:41], v3 offset:57856
  ds_read_b64_tr_b16 v[42:43], v3 offset:59904
  v_mfma_f32_16x16x32_bf16 v[220:223], v[28:31], v[76:79], v[220:223]
  ds_read_b64_tr_b16 v[44:45], v3 offset:61952
  s_waitcnt lgkmcnt(3)
  v_mfma_f32_16x16x32_bf16 v[224:227], v[32:35], v[48:51], v[224:227]
  ds_read_b64_tr_b16 v[46:47], v3 offset:64000
  v_mfma_f32_16x16x32_bf16 v[224:227], v[36:39], v[52:55], v[224:227]
  v_exp_f32 v8, v120
  v_mfma_f32_16x16x32_bf16 v[228:231], v[32:35], v[56:59], v[228:231]
  v_exp_f32 v9, v121
  v_mfma_f32_16x16x32_bf16 v[228:231], v[36:39], v[60:63], v[228:231]
  buffer_load_dwordx4 v5, s[12:15], s59 offen offset:3072 lds
  v_add_f32 v14, v14, v8
  v_mfma_f32_16x16x32_bf16 v[232:235], v[32:35], v[64:67], v[232:235]
  ds_read_b128 v[16:19], v1 offset:0
  v_cvt_pk_bf16_f32 v102, v8, v9
  v_mfma_f32_16x16x32_bf16 v[232:235], v[36:39], v[68:71], v[232:235]
  ds_read_b128 v[20:23], v1 offset:512
  v_add_f32 v14, v14, v9
  v_mfma_f32_16x16x32_bf16 v[236:239], v[32:35], v[72:75], v[236:239]
  ds_read_b128 v[24:27], v1 offset:2048
  v_mfma_f32_16x16x32_bf16 v[236:239], v[36:39], v[76:79], v[236:239]
  ds_read_b128 v[28:31], v1 offset:2560
  s_waitcnt lgkmcnt(4)
  v_mfma_f32_16x16x32_bf16 v[240:243], v[40:43], v[48:51], v[240:243]
  ds_read_b128 v[32:35], v1 offset:4096
  v_mfma_f32_16x16x32_bf16 v[240:243], v[44:47], v[52:55], v[240:243]
  ds_read_b128 v[36:39], v1 offset:4608
  v_mfma_f32_16x16x32_bf16 v[244:247], v[40:43], v[56:59], v[244:247]
  v_exp_f32 v10, v122
  v_mfma_f32_16x16x32_bf16 v[244:247], v[44:47], v[60:63], v[244:247]
  v_exp_f32 v11, v123
  v_mfma_f32_16x16x32_bf16 v[248:251], v[40:43], v[64:67], v[248:251]
  v_add_f32 v14, v14, v10
  v_cvt_pk_bf16_f32 v103, v10, v11
  v_mfma_f32_16x16x32_bf16 v[248:251], v[44:47], v[68:71], v[248:251]
  v_add_f32 v14, v14, v11
  v_mfma_f32_16x16x32_bf16 v[252:255], v[40:43], v[72:75], v[252:255]
  ds_read_b128 v[40:43], v1 offset:6144
  v_mfma_f32_16x16x32_bf16 v[252:255], v[44:47], v[76:79], v[252:255]
  s_sub_u32 s26, s26, 1
  s_cmp_lg_u32 s26, 0
  s_cbranch_scc1 L_loop
  v_exp_f32 v8, v124
  v_exp_f32 v9, v125
  v_add_f32 v15, v15, v8
  v_cvt_pk_bf16_f32 v110, v8, v9
  v_add_f32 v15, v15, v9
  v_exp_f32 v10, v126
  v_exp_f32 v11, v127
  v_add_f32 v15, v15, v10
  v_cvt_pk_bf16_f32 v111, v10, v11
  v_add_f32 v15, v15, v11
L_fin:
  s_waitcnt vmcnt(0) lgkmcnt(0)
  s_barrier
  s_add_u32 m0, s25, 57344
  s_nop 0
  buffer_load_dwordx4 v5, s[12:15], s60 offen offset:0 lds
  buffer_load_dwordx4 v5, s[12:15], s61 offen offset:1024 lds
  buffer_load_dwordx4 v5, s[12:15], s62 offen offset:2048 lds
  buffer_load_dwordx4 v5, s[12:15], s63 offen offset:3072 lds
  ds_read_b64_tr_b16 v[16:17], v2 offset:8192
  ds_read_b64_tr_b16 v[18:19], v2 offset:10240
  ds_read_b64_tr_b16 v[20:21], v2 offset:12288
  ds_read_b64_tr_b16 v[22:23], v2 offset:14336
  ds_read_b64_tr_b16 v[24:25], v3 offset:8192
  ds_read_b64_tr_b16 v[26:27], v3 offset:10240
  ds_read_b64_tr_b16 v[28:29], v3 offset:12288
  ds_read_b64_tr_b16 v[30:31], v3 offset:14336
  s_waitcnt lgkmcnt(4)
  v_mfma_f32_16x16x32_bf16 a[128:131], v[16:19], v[80:83], a[128:131]
  v_mfma_f32_16x16x32_bf16 a[128:131], v[20:23], v[84:87], a[128:131]
  v_and_b32 v1, 63, v0
  v_mov_b32 v8, v12
  v_mfma_f32_16x16x32_bf16 a[132:135], v[16:19], v[88:91], a[132:135]
  v_mov_b32 v9, v13
  v_mov_b32 v10, v14
  v_mfma_f32_16x16x32_bf16 a[132:135], v[20:23], v[92:95], a[132:135]
  v_mov_b32 v11, v15
  v_permlane32_swap_b32 v12, v8
  v_mfma_f32_16x16x32_bf16 a[136:139], v[16:19], v[96:99], a[136:139]
  v_permlane32_swap_b32 v13, v9
  v_permlane32_swap_b32 v14, v10
  v_mfma_f32_16x16x32_bf16 a[136:139], v[20:23], v[100:103], a[136:139]
  v_permlane32_swap_b32 v15, v11
  v_add_f32 v12, v12, v8
  v_mfma_f32_16x16x32_bf16 a[140:143], v[16:19], v[104:107], a[140:143]
  v_add_f32 v13, v13, v9
  v_add_f32 v14, v14, v10
  v_mfma_f32_16x16x32_bf16 a[140:143], v[20:23], v[108:111], a[140:143]
  v_add_f32 v15, v15, v11
  s_waitcnt lgkmcnt(0)
  v_mfma_f32_16x16x32_bf16 a[144:147], v[24:27], v[80:83], a[144:147]
  ds_read_b64_tr_b16 v[32:33], v2 offset:8704
  ds_read_b64_tr_b16 v[34:35], v2 offset:10752
  v_mfma_f32_16x16x32_bf16 a[144:147], v[28:31], v[84:87], a[144:147]
  v_mov_b32 v8, v12
  v_mov_b32 v9, v13
  v_mfma_f32_16x16x32_bf16 a[148:151], v[24:27], v[88:91], a[148:151]
  ds_read_b64_tr_b16 v[36:37], v2 offset:12800
  ds_read_b64_tr_b16 v[38:39], v2 offset:14848
  v_mov_b32 v10, v14
  v_mov_b32 v11, v15
  v_mfma_f32_16x16x32_bf16 a[148:151], v[28:31], v[92:95], a[148:151]
  v_permlane16_swap_b32 v12, v8
  v_permlane16_swap_b32 v13, v9
  v_mfma_f32_16x16x32_bf16 a[152:155], v[24:27], v[96:99], a[152:155]
  v_permlane16_swap_b32 v14, v10
  v_permlane16_swap_b32 v15, v11
  v_mfma_f32_16x16x32_bf16 a[152:155], v[28:31], v[100:103], a[152:155]
  v_add_f32 v12, v12, v8
  v_add_f32 v13, v13, v9
  v_mfma_f32_16x16x32_bf16 a[156:159], v[24:27], v[104:107], a[156:159]
  v_add_f32 v14, v14, v10
  v_add_f32 v15, v15, v11
  v_mfma_f32_16x16x32_bf16 a[156:159], v[28:31], v[108:111], a[156:159]
  v_and_b32 v6, 15, v1
  v_lshlrev_b32 v6, 4, v6
  s_waitcnt lgkmcnt(0)
  v_mfma_f32_16x16x32_bf16 a[160:163], v[32:35], v[80:83], a[160:163]
  v_add_u32 v6, s73, v6
  ds_write_b128 v6, v[12:15]
  v_mfma_f32_16x16x32_bf16 a[160:163], v[36:39], v[84:87], a[160:163]
  ds_read_b64_tr_b16 v[40:41], v3 offset:8704
  ds_read_b64_tr_b16 v[42:43], v3 offset:10752
  v_xor_b32 v6, 256, v6
  v_lshlrev_b32 v7, 2, v1
  v_mfma_f32_16x16x32_bf16 a[164:167], v[32:35], v[88:91], a[164:167]
  ds_read_b64_tr_b16 v[44:45], v3 offset:12800
  ds_read_b64_tr_b16 v[46:47], v3 offset:14848
  v_add_u32 v7, 131072, v7
  v_lshlrev_b32 v8, 4, v1
  v_mfma_f32_16x16x32_bf16 a[164:167], v[36:39], v[92:95], a[164:167]
  v_add_u32 v112, s68, v8
  v_add_u32 v115, s69, v8
  v_mfma_f32_16x16x32_bf16 a[168:171], v[32:35], v[96:99], a[168:171]
  v_add_u32 v113, s70, v8
  v_add_u32 v114, s72, v113
  v_mfma_f32_16x16x32_bf16 a[168:171], v[36:39], v[100:103], a[168:171]
  v_add_u32 v116, s71, v8
  v_add_u32 v117, s72, v116
  v_mfma_f32_16x16x32_bf16 a[172:175], v[32:35], v[104:107], a[172:175]
  v_and_b32 v8, 15, v1
  v_mul_u32_u24 v8, 144, v8
  v_mfma_f32_16x16x32_bf16 a[172:175], v[36:39], v[108:111], a[172:175]
  v_lshrrev_b32 v9, 5, v1
  v_lshl_add_u32 v8, v9, 4, v8
  s_waitcnt lgkmcnt(0)
  v_mfma_f32_16x16x32_bf16 a[176:179], v[40:43], v[80:83], a[176:179]
  v_bfe_u32 v9, v1, 4, 1
  v_lshl_add_u32 v8, v9, 3, v8
  v_mfma_f32_16x16x32_bf16 a[176:179], v[44:47], v[84:87], a[176:179]
  ds_read_b64_tr_b16 v[16:17], v2 offset:40960
  ds_read_b64_tr_b16 v[18:19], v2 offset:43008
  v_add_u32 v118, s69, v8
  v_add_u32 v119, s71, v8
  v_mfma_f32_16x16x32_bf16 a[180:183], v[40:43], v[88:91], a[180:183]
  ds_read_b64_tr_b16 v[20:21], v2 offset:45056
  ds_read_b64_tr_b16 v[22:23], v2 offset:47104
  v_add_u32 v120, s72, v119
  v_lshrrev_b32 v8, 3, v1
  v_mfma_f32_16x16x32_bf16 a[180:183], v[44:47], v[92:95], a[180:183]
  v_mul_u32_u24 v9, 144, v8
  v_and_b32 v10, 7, v1
  v_mfma_f32_16x16x32_bf16 a[184:187], v[40:43], v[96:99], a[184:187]
  v_lshl_add_u32 v9, v10, 4, v9
  v_add_u32 v121, s69, v9
  v_mfma_f32_16x16x32_bf16 a[184:187], v[44:47], v[100:103], a[184:187]
  v_add_u32 v122, s71, v9
  v_add_u32 v123, s72, v122
  v_mfma_f32_16x16x32_bf16 a[188:191], v[40:43], v[104:107], a[188:191]
  v_lshlrev_b32 v8, 9, v8
  v_lshl_add_u32 v124, v10, 4, v8
  v_mfma_f32_16x16x32_bf16 a[188:191], v[44:47], v[108:111], a[188:191]
  v_add_u32 v124, s74, v124
  v_add_u32 v125, 4096, v124
  s_waitcnt lgkmcnt(0)
  s_barrier
  v_mfma_f32_16x16x32_bf16 v[128:131], v[16:19], v[80:83], v[128:131]
  ds_read_b64_tr_b16 v[24:25], v3 offset:40960
  ds_read_b64_tr_b16 v[26:27], v3 offset:43008
  v_mfma_f32_16x16x32_bf16 v[128:131], v[20:23], v[84:87], v[128:131]
  ds_read_b64_tr_b16 v[28:29], v3 offset:45056
  ds_read_b64_tr_b16 v[30:31], v3 offset:47104
  v_mfma_f32_16x16x32_bf16 v[132:135], v[16:19], v[88:91], v[132:135]
  ds_read_b128 v[48:51], v6
  ds_read_b32 v52, v7 offset:0
  v_mfma_f32_16x16x32_bf16 v[132:135], v[20:23], v[92:95], v[132:135]
  ds_read_b32 v53, v7 offset:256
  ds_write_b128 v112, a[128:131] offset:0
  v_mfma_f32_16x16x32_bf16 v[136:139], v[16:19], v[96:99], v[136:139]
  ds_read_b32 v54, v7 offset:512
  ds_write_b128 v112, a[144:147] offset:1024
  v_mfma_f32_16x16x32_bf16 v[136:139], v[20:23], v[100:103], v[136:139]
  ds_read_b32 v55, v7 offset:768
  s_waitcnt lgkmcnt(6)
  v_mfma_f32_16x16x32_bf16 v[140:143], v[16:19], v[104:107], v[140:143]
  ds_write_b128 v112, a[160:163] offset:2048
  v_add_f32 v12, v12, v48
  v_mfma_f32_16x16x32_bf16 v[140:143], v[20:23], v[108:111], v[140:143]
  v_add_f32 v13, v13, v49
  v_mfma_f32_16x16x32_bf16 v[144:147], v[24:27], v[80:83], v[144:147]
  ds_write_b128 v112, a[176:179] offset:3072
  ds_read_b64_tr_b16 v[32:33], v2 offset:41472
  v_mfma_f32_16x16x32_bf16 v[144:147], v[28:31], v[84:87], v[144:147]
  ds_read_b64_tr_b16 v[34:35], v2 offset:43520
  v_add_f32 v14, v14, v50
  v_add_f32 v15, v15, v51
  v_mfma_f32_16x16x32_bf16 v[148:151], v[24:27], v[88:91], v[148:151]
  ds_read_b64_tr_b16 v[36:37], v2 offset:45568
  ds_read_b64_tr_b16 v[38:39], v2 offset:47616
  v_rcp_f32 v12, v12
  ds_write_b128 v112, a[132:135] offset:4096
  v_mfma_f32_16x16x32_bf16 v[148:151], v[28:31], v[92:95], v[148:151]
  v_rcp_f32 v13, v13
  v_mfma_f32_16x16x32_bf16 v[152:155], v[24:27], v[96:99], v[152:155]
  v_rcp_f32 v14, v14
  ds_write_b128 v112, a[148:151] offset:5120
  v_mfma_f32_16x16x32_bf16 v[152:155], v[28:31], v[100:103], v[152:155]
  v_rcp_f32 v15, v15
  ds_write_b128 v112, a[164:167] offset:6144
  v_mfma_f32_16x16x32_bf16 v[156:159], v[24:27], v[104:107], v[156:159]
  s_waitcnt lgkmcnt(9)
  v_add_f32 v52, v52, v53
  v_mfma_f32_16x16x32_bf16 v[156:159], v[28:31], v[108:111], v[156:159]
  ds_write_b128 v112, a[180:183] offset:7168
  s_waitcnt lgkmcnt(4)
  v_mfma_f32_16x16x32_bf16 v[160:163], v[32:35], v[80:83], v[160:163]
  v_add_f32 v54, v54, v55
  ds_read_b64_tr_b16 v[40:41], v3 offset:41472
  v_mfma_f32_16x16x32_bf16 v[160:163], v[36:39], v[84:87], v[160:163]
  ds_read_b64_tr_b16 v[42:43], v3 offset:43520
  s_mov_b32 s76, 0x39800000
  s_mov_b32 s77, 0x51800000
  ds_write_b128 v112, a[136:139] offset:16384
  v_mfma_f32_16x16x32_bf16 v[164:167], v[32:35], v[88:91], v[164:167]
  ds_read_b64_tr_b16 v[44:45], v3 offset:45568
  ds_read_b64_tr_b16 v[46:47], v3 offset:47616
  s_mov_b64 s[78:79], -1
  v_mfma_f32_16x16x32_bf16 v[164:167], v[36:39], v[92:95], v[164:167]
  v_cmp_lt_f32 vcc, s76, v52
  ds_write_b128 v112, a[152:155] offset:17408
  v_mfma_f32_16x16x32_bf16 v[168:171], v[32:35], v[96:99], v[168:171]
  s_nop 0
  s_and_b64 s[78:79], s[78:79], vcc
  v_mfma_f32_16x16x32_bf16 v[168:171], v[36:39], v[100:103], v[168:171]
  ds_write_b128 v112, a[168:171] offset:18432
  v_cmp_gt_f32 vcc, s77, v52
  v_mfma_f32_16x16x32_bf16 v[172:175], v[32:35], v[104:107], v[172:175]
  ds_write_b128 v112, a[184:187] offset:19456
  s_nop 0
  v_mfma_f32_16x16x32_bf16 v[172:175], v[36:39], v[108:111], v[172:175]
  s_and_b64 s[78:79], s[78:79], vcc
  s_waitcnt lgkmcnt(3)
  v_mfma_f32_16x16x32_bf16 v[176:179], v[40:43], v[80:83], v[176:179]
  v_cmp_lt_f32 vcc, s76, v54
  ds_write_b128 v112, a[140:143] offset:20480
  v_mfma_f32_16x16x32_bf16 v[176:179], v[44:47], v[84:87], v[176:179]
  ds_read_b64_tr_b16 v[16:17], v2 offset:24576
  ds_read_b64_tr_b16 v[18:19], v2 offset:26624
  s_nop 0
  v_mfma_f32_16x16x32_bf16 v[180:183], v[40:43], v[88:91], v[180:183]
  ds_read_b64_tr_b16 v[20:21], v2 offset:28672
  ds_read_b64_tr_b16 v[22:23], v2 offset:30720
  s_and_b64 s[78:79], s[78:79], vcc
  ds_write_b128 v112, a[156:159] offset:21504
  v_mfma_f32_16x16x32_bf16 v[180:183], v[44:47], v[92:95], v[180:183]
  v_cmp_gt_f32 vcc, s77, v54
  s_nop 0
  v_mfma_f32_16x16x32_bf16 v[184:187], v[40:43], v[96:99], v[184:187]
  ds_write_b128 v112, a[172:175] offset:22528
  s_and_b64 s[78:79], s[78:79], vcc
  v_mfma_f32_16x16x32_bf16 v[184:187], v[44:47], v[100:103], v[184:187]
  s_cmp_lg_u64 s[78:79], -1
  ds_write_b128 v112, a[188:191] offset:23552
  v_mfma_f32_16x16x32_bf16 v[188:191], v[40:43], v[104:107], v[188:191]
  s_cselect_b32 s31, 1, 0
  ds_read_b64_tr_b16 v[24:25], v3 offset:24576
  v_mfma_f32_16x16x32_bf16 v[188:191], v[44:47], v[108:111], v[188:191]
  s_waitcnt lgkmcnt(1)
  s_waitcnt vmcnt(0)
  s_barrier
  v_mfma_f32_16x16x32_bf16 a[192:195], v[16:19], v[80:83], a[192:195]
  ds_read_b64_tr_b16 v[26:27], v3 offset:26624
  ds_read_b64_tr_b16 v[28:29], v3 offset:28672
  v_mfma_f32_16x16x32_bf16 a[192:195], v[20:23], v[84:87], a[192:195]
  ds_read_b64_tr_b16 v[30:31], v3 offset:30720
  ds_read_b128 v[48:51], v115 offset:0
  v_mfma_f32_16x16x32_bf16 a[196:199], v[16:19], v[88:91], a[196:199]
  ds_read_b128 v[52:55], v115 offset:1024
  ds_read_b128 v[56:59], v115 offset:2048
  ds_read_b128 v[60:63], v115 offset:3072
  v_mfma_f32_16x16x32_bf16 a[196:199], v[20:23], v[92:95], a[196:199]
  ds_read_b128 v[64:67], v115 offset:4096
  ds_read_b128 v[68:71], v115 offset:5120
  ds_read_b128 v[72:75], v115 offset:6144
  v_mfma_f32_16x16x32_bf16 a[200:203], v[16:19], v[96:99], a[200:203]
  ds_read_b128 v[76:79], v115 offset:7168
  s_waitcnt lgkmcnt(4)
  v_add_f32 v48, v48, v128
  v_add_f32 v49, v49, v129
  v_mfma_f32_16x16x32_bf16 a[200:203], v[20:23], v[100:103], a[200:203]
  v_add_f32 v50, v50, v130
  v_add_f32 v51, v51, v131
  v_mul_f32 v48, v48, v12
  v_mfma_f32_16x16x32_bf16 a[204:207], v[16:19], v[104:107], a[204:207]
  v_mul_f32 v49, v49, v12
  v_mul_f32 v50, v50, v12
  v_mul_f32 v51, v51, v12
  v_cvt_pk_bf16_f32 v48, v48, v49
  v_mfma_f32_16x16x32_bf16 a[204:207], v[20:23], v[108:111], a[204:207]
  v_cvt_pk_bf16_f32 v49, v50, v51
  ds_write_b64 v118, v[48:49] offset:0
  v_add_f32 v52, v52, v144
  v_mfma_f32_16x16x32_bf16 a[208:211], v[24:27], v[80:83], a[208:211]
  v_add_f32 v53, v53, v145
  v_add_f32 v54, v54, v146
  v_add_f32 v55, v55, v147
  v_mul_f32 v52, v52, v12
  v_mfma_f32_16x16x32_bf16 a[208:211], v[28:31], v[84:87], a[208:211]
  ds_read_b64_tr_b16 v[32:33], v2 offset:25088
  ds_read_b64_tr_b16 v[34:35], v2 offset:27136
  v_mul_f32 v53, v53, v12
  v_mul_f32 v54, v54, v12
  v_mul_f32 v55, v55, v12
  v_mfma_f32_16x16x32_bf16 a[212:215], v[24:27], v[88:91], a[212:215]
  ds_read_b64_tr_b16 v[36:37], v2 offset:29184
  ds_read_b64_tr_b16 v[38:39], v2 offset:31232
  v_cvt_pk_bf16_f32 v52, v52, v53
  v_cvt_pk_bf16_f32 v53, v54, v55
  ds_write_b64 v118, v[52:53] offset:32
  v_add_f32 v56, v56, v160
  v_mfma_f32_16x16x32_bf16 a[212:215], v[28:31], v[92:95], a[212:215]
  v_add_f32 v57, v57, v161
  v_add_f32 v58, v58, v162
  v_add_f32 v59, v59, v163
  v_mfma_f32_16x16x32_bf16 a[216:219], v[24:27], v[96:99], a[216:219]
  v_mul_f32 v56, v56, v12
  v_mul_f32 v57, v57, v12
  v_mul_f32 v58, v58, v12
  v_mul_f32 v59, v59, v12
  v_mfma_f32_16x16x32_bf16 a[216:219], v[28:31], v[100:103], a[216:219]
  v_cvt_pk_bf16_f32 v56, v56, v57
  v_cvt_pk_bf16_f32 v57, v58, v59
  ds_write_b64 v118, v[56:57] offset:64
  v_mfma_f32_16x16x32_bf16 a[220:223], v[24:27], v[104:107], a[220:223]
  ds_write_b128 v113, a[192:195] offset:0
  v_add_f32 v60, v60, v176
  v_add_f32 v61, v61, v177
  v_add_f32 v62, v62, v178
  v_add_f32 v63, v63, v179
  v_mfma_f32_16x16x32_bf16 a[220:223], v[28:31], v[108:111], a[220:223]
  v_mul_f32 v60, v60, v12
  v_mul_f32 v61, v61, v12
  v_mul_f32 v62, v62, v12
  s_waitcnt lgkmcnt(3)
  v_mfma_f32_16x16x32_bf16 a[224:227], v[32:35], v[80:83], a[224:227]
  v_mul_f32 v63, v63, v12
  v_cvt_pk_bf16_f32 v60, v60, v61
  v_cvt_pk_bf16_f32 v61, v62, v63
  ds_write_b64 v118, v[60:61] offset:96
  v_mfma_f32_16x16x32_bf16 a[224:227], v[36:39], v[84:87], a[224:227]
  ds_read_b64_tr_b16 v[40:41], v3 offset:25088
  ds_read_b64_tr_b16 v[42:43], v3 offset:27136
  ds_write_b128 v113, a[196:199] offset:4096
  ds_read_b128 v[48:51], v121 offset:0
  ds_read_b128 v[52:55], v121 offset:1152
  v_mfma_f32_16x16x32_bf16 a[228:231], v[32:35], v[88:91], a[228:231]
  ds_read_b64_tr_b16 v[44:45], v3 offset:29184
  ds_read_b64_tr_b16 v[46:47], v3 offset:31232
  v_add_f32 v64, v64, v132
  v_add_f32 v65, v65, v133
  v_add_f32 v66, v66, v134
  v_add_f32 v67, v67, v135
  v_mfma_f32_16x16x32_bf16 a[228:231], v[36:39], v[92:95], a[228:231]
  v_mul_f32 v64, v64, v13
  v_mul_f32 v65, v65, v13
  v_mul_f32 v66, v66, v13
  v_mfma_f32_16x16x32_bf16 a[232:235], v[32:35], v[96:99], a[232:235]
  ds_write_b128 v114, a[200:203] offset:0
  v_mul_f32 v67, v67, v13
  v_cvt_pk_bf16_f32 v64, v64, v65
  v_cvt_pk_bf16_f32 v65, v66, v67
  ds_write_b64 v118, v[64:65] offset:4096
  v_mfma_f32_16x16x32_bf16 a[232:235], v[36:39], v[100:103], a[232:235]
  s_waitcnt lgkmcnt(4)
  buffer_store_dwordx4 v[48:51], v124, s[16:19], s64 offen offset:0 sc1 nt
  buffer_store_dwordx4 v[52:55], v125, s[16:19], s64 offen offset:0 sc1 nt
  v_mfma_f32_16x16x32_bf16 a[236:239], v[32:35], v[104:107], a[236:239]
  ds_read_b128 v[48:51], v115 offset:16384
  ds_read_b128 v[52:55], v115 offset:17408
  ds_read_b128 v[56:59], v115 offset:18432
  ds_read_b128 v[60:63], v115 offset:19456
  v_mfma_f32_16x16x32_bf16 a[236:239], v[36:39], v[108:111], a[236:239]
  ds_write_b128 v114, a[204:207] offset:4096
  v_add_f32 v68, v68, v148
  v_add_f32 v69, v69, v149
  v_add_f32 v70, v70, v150
  s_waitcnt lgkmcnt(7)
  v_mfma_f32_16x16x32_bf16 a[240:243], v[40:43], v[80:83], a[240:243]
  v_add_f32 v71, v71, v151
  v_mul_f32 v68, v68, v13
  v_mul_f32 v69, v69, v13
  v_mul_f32 v70, v70, v13
  v_mfma_f32_16x16x32_bf16 a[240:243], v[44:47], v[84:87], a[240:243]
  ds_read_b64_tr_b16 v[16:17], v2 offset:57344
  ds_read_b64_tr_b16 v[18:19], v2 offset:59392
  v_mul_f32 v71, v71, v13
  v_cvt_pk_bf16_f32 v68, v68, v69
  v_cvt_pk_bf16_f32 v69, v70, v71
  v_mfma_f32_16x16x32_bf16 a[244:247], v[40:43], v[88:91], a[244:247]
  ds_read_b64_tr_b16 v[20:21], v2 offset:61440
  ds_read_b64_tr_b16 v[22:23], v2 offset:63488
  ds_write_b128 v113, a[208:211] offset:1024
  ds_write_b64 v118, v[68:69] offset:4128
  v_add_f32 v72, v72, v164
  v_add_f32 v73, v73, v165
  v_add_f32 v74, v74, v166
  v_mfma_f32_16x16x32_bf16 a[244:247], v[44:47], v[92:95], a[244:247]
  v_add_f32 v75, v75, v167
  v_mul_f32 v72, v72, v13
  v_mul_f32 v73, v73, v13
  v_mfma_f32_16x16x32_bf16 a[248:251], v[40:43], v[96:99], a[248:251]
  v_mul_f32 v74, v74, v13
  v_mul_f32 v75, v75, v13
  v_cvt_pk_bf16_f32 v72, v72, v73
  v_cvt_pk_bf16_f32 v73, v74, v75
  v_mfma_f32_16x16x32_bf16 a[248:251], v[44:47], v[100:103], a[248:251]
  ds_write_b128 v113, a[212:215] offset:5120
  ds_write_b64 v118, v[72:73] offset:4160
  v_add_f32 v76, v76, v180
  v_add_f32 v77, v77, v181
  v_mfma_f32_16x16x32_bf16 a[252:255], v[40:43], v[104:107], a[252:255]
  v_add_f32 v78, v78, v182
  v_add_f32 v79, v79, v183
  v_mul_f32 v76, v76, v13
  v_mul_f32 v77, v77, v13
  v_mfma_f32_16x16x32_bf16 a[252:255], v[44:47], v[108:111], a[252:255]
  v_mul_f32 v78, v78, v13
  v_mul_f32 v79, v79, v13
  v_cvt_pk_bf16_f32 v76, v76, v77
  s_waitcnt lgkmcnt(4)
  v_mfma_f32_16x16x32_bf16 v[192:195], v[16:19], v[80:83], v[192:195]
  ds_write_b128 v114, a[216:219] offset:1024
  v_cvt_pk_bf16_f32 v77, v78, v79
  ds_write_b64 v118, v[76:77] offset:4192
  ds_read_b128 v[64:67], v121 offset:4096
  v_mfma_f32_16x16x32_bf16 v[192:195], v[20:23], v[84:87], v[192:195]
  ds_read_b64_tr_b16 v[24:25], v3 offset:57344
  ds_read_b64_tr_b16 v[26:27], v3 offset:59392
  ds_read_b128 v[68:71], v121 offset:5248
  v_add_f32 v48, v48, v136
  v_add_f32 v49, v49, v137
  v_mfma_f32_16x16x32_bf16 v[196:199], v[16:19], v[88:91], v[196:199]
  ds_read_b64_tr_b16 v[28:29], v3 offset:61440
  ds_read_b64_tr_b16 v[30:31], v3 offset:63488
  v_add_f32 v50, v50, v138
  v_add_f32 v51, v51, v139
  v_mul_f32 v48, v48, v14
  v_mfma_f32_16x16x32_bf16 v[196:199], v[20:23], v[92:95], v[196:199]
  ds_write_b128 v114, a[220:223] offset:5120
  v_mul_f32 v49, v49, v14
  v_mul_f32 v50, v50, v14
  v_mul_f32 v51, v51, v14
  v_cvt_pk_bf16_f32 v48, v48, v49
  v_mfma_f32_16x16x32_bf16 v[200:203], v[16:19], v[96:99], v[200:203]
  v_cvt_pk_bf16_f32 v49, v50, v51
  ds_write_b64 v118, v[48:49] offset:16384
  s_waitcnt lgkmcnt(4)
  v_mfma_f32_16x16x32_bf16 v[200:203], v[20:23], v[100:103], v[200:203]
  buffer_store_dwordx4 v[64:67], v124, s[16:19], s65 offen offset:0 sc1 nt
  buffer_store_dwordx4 v[68:71], v125, s[16:19], s65 offen offset:0 sc1 nt
  ds_read_b128 v[64:67], v115 offset:20480
  ds_read_b128 v[68:71], v115 offset:21504
  v_mfma_f32_16x16x32_bf16 v[204:207], v[16:19], v[104:107], v[204:207]
  ds_read_b128 v[72:75], v115 offset:22528
  ds_read_b128 v[76:79], v115 offset:23552
  v_add_f32 v52, v52, v152
  v_mfma_f32_16x16x32_bf16 v[204:207], v[20:23], v[108:111], v[204:207]
  ds_write_b128 v113, a[224:227] offset:2048
  v_add_f32 v53, v53, v153
  v_add_f32 v54, v54, v154
  v_add_f32 v55, v55, v155
  v_mul_f32 v52, v52, v14
  s_waitcnt lgkmcnt(7)
  v_mfma_f32_16x16x32_bf16 v[208:211], v[24:27], v[80:83], v[208:211]
  v_mul_f32 v53, v53, v14
  v_mul_f32 v54, v54, v14
  v_mul_f32 v55, v55, v14
  v_mfma_f32_16x16x32_bf16 v[208:211], v[28:31], v[84:87], v[208:211]
  ds_read_b64_tr_b16 v[32:33], v2 offset:57856
  ds_read_b64_tr_b16 v[34:35], v2 offset:59904
  v_cvt_pk_bf16_f32 v52, v52, v53
  v_cvt_pk_bf16_f32 v53, v54, v55
  ds_write_b64 v118, v[52:53] offset:16416
  v_add_f32 v56, v56, v168
  v_mfma_f32_16x16x32_bf16 v[212:215], v[24:27], v[88:91], v[212:215]
  ds_read_b64_tr_b16 v[36:37], v2 offset:61952
  ds_read_b64_tr_b16 v[38:39], v2 offset:64000
  ds_write_b128 v113, a[228:231] offset:6144
  v_add_f32 v57, v57, v169
  v_add_f32 v58, v58, v170
  v_add_f32 v59, v59, v171
  v_mfma_f32_16x16x32_bf16 v[212:215], v[28:31], v[92:95], v[212:215]
  v_mul_f32 v56, v56, v14
  v_mul_f32 v57, v57, v14
  v_mul_f32 v58, v58, v14
  v_mul_f32 v59, v59, v14
  v_mfma_f32_16x16x32_bf16 v[216:219], v[24:27], v[96:99], v[216:219]
  v_cvt_pk_bf16_f32 v56, v56, v57
  v_cvt_pk_bf16_f32 v57, v58, v59
  ds_write_b64 v118, v[56:57] offset:16448
  v_mfma_f32_16x16x32_bf16 v[216:219], v[28:31], v[100:103], v[216:219]
  ds_write_b128 v114, a[232:235] offset:2048
  v_add_f32 v60, v60, v184
  v_add_f32 v61, v61, v185
  v_add_f32 v62, v62, v186
  v_add_f32 v63, v63, v187
  v_mfma_f32_16x16x32_bf16 v[220:223], v[24:27], v[104:107], v[220:223]
  v_mul_f32 v60, v60, v14
  v_mul_f32 v61, v61, v14
  v_mul_f32 v62, v62, v14
  v_mfma_f32_16x16x32_bf16 v[220:223], v[28:31], v[108:111], v[220:223]
  v_mul_f32 v63, v63, v14
  v_cvt_pk_bf16_f32 v60, v60, v61
  v_cvt_pk_bf16_f32 v61, v62, v63
  s_waitcnt lgkmcnt(10)
  ds_write_b64 v118, v[60:61] offset:16480
  s_waitcnt lgkmcnt(4)
  v_mfma_f32_16x16x32_bf16 v[224:227], v[32:35], v[80:83], v[224:227]
  ds_write_b128 v114, a[236:239] offset:6144
  ds_read_b128 v[48:51], v121 offset:16384
  ds_read_b128 v[52:55], v121 offset:17536
  v_mfma_f32_16x16x32_bf16 v[224:227], v[36:39], v[84:87], v[224:227]
  ds_read_b64_tr_b16 v[40:41], v3 offset:57856
  ds_read_b64_tr_b16 v[42:43], v3 offset:59904
  v_add_f32 v64, v64, v140
  v_add_f32 v65, v65, v141
  v_add_f32 v66, v66, v142
  v_add_f32 v67, v67, v143
  v_mfma_f32_16x16x32_bf16 v[228:231], v[32:35], v[88:91], v[228:231]
  ds_read_b64_tr_b16 v[44:45], v3 offset:61952
  ds_read_b64_tr_b16 v[46:47], v3 offset:64000
  v_mul_f32 v64, v64, v15
  v_mul_f32 v65, v65, v15
  v_mul_f32 v66, v66, v15
  v_mfma_f32_16x16x32_bf16 v[228:231], v[36:39], v[92:95], v[228:231]
  ds_write_b128 v113, a[240:243] offset:3072
  v_mul_f32 v67, v67, v15
  v_cvt_pk_bf16_f32 v64, v64, v65
  v_cvt_pk_bf16_f32 v65, v66, v67
  ds_write_b64 v118, v[64:65] offset:20480
  v_mfma_f32_16x16x32_bf16 v[232:235], v[32:35], v[96:99], v[232:235]
  s_waitcnt lgkmcnt(6)
  buffer_store_dwordx4 v[48:51], v124, s[16:19], s66 offen offset:0 sc1 nt
  buffer_store_dwordx4 v[52:55], v125, s[16:19], s66 offen offset:0 sc1 nt
  v_mfma_f32_16x16x32_bf16 v[232:235], v[36:39], v[100:103], v[232:235]
  v_add_f32 v68, v68, v156
  v_add_f32 v69, v69, v157
  v_add_f32 v70, v70, v158
  v_add_f32 v71, v71, v159
  v_mfma_f32_16x16x32_bf16 v[236:239], v[32:35], v[104:107], v[236:239]
  ds_write_b128 v113, a[244:247] offset:7168
  v_mul_f32 v68, v68, v15
  v_mul_f32 v69, v69, v15
  v_mul_f32 v70, v70, v15
  v_mfma_f32_16x16x32_bf16 v[236:239], v[36:39], v[108:111], v[236:239]
  v_mul_f32 v71, v71, v15
  v_cvt_pk_bf16_f32 v68, v68, v69
  v_cvt_pk_bf16_f32 v69, v70, v71
  ds_write_b64 v118, v[68:69] offset:20512
  s_waitcnt lgkmcnt(4)
  v_mfma_f32_16x16x32_bf16 v[240:243], v[40:43], v[80:83], v[240:243]
  v_add_f32 v72, v72, v172
  v_add_f32 v73, v73, v173
  v_add_f32 v74, v74, v174
  v_mfma_f32_16x16x32_bf16 v[240:243], v[44:47], v[84:87], v[240:243]
  ds_write_b128 v114, a[248:251] offset:3072
  v_add_f32 v75, v75, v175
  v_mul_f32 v72, v72, v15
  v_mul_f32 v73, v73, v15
  v_mul_f32 v74, v74, v15
  v_mfma_f32_16x16x32_bf16 v[244:247], v[40:43], v[88:91], v[244:247]
  v_mul_f32 v75, v75, v15
  v_cvt_pk_bf16_f32 v72, v72, v73
  v_cvt_pk_bf16_f32 v73, v74, v75
  v_mfma_f32_16x16x32_bf16 v[244:247], v[44:47], v[92:95], v[244:247]
  ds_write_b64 v118, v[72:73] offset:20544
  v_add_f32 v76, v76, v188
  v_add_f32 v77, v77, v189
  v_add_f32 v78, v78, v190
  v_mfma_f32_16x16x32_bf16 v[248:251], v[40:43], v[96:99], v[248:251]
  ds_write_b128 v114, a[252:255] offset:7168
  v_add_f32 v79, v79, v191
  v_mul_f32 v76, v76, v15
  v_mul_f32 v77, v77, v15
  v_mfma_f32_16x16x32_bf16 v[248:251], v[44:47], v[100:103], v[248:251]
  v_mul_f32 v78, v78, v15
  v_mul_f32 v79, v79, v15
  v_cvt_pk_bf16_f32 v76, v76, v77
  v_cvt_pk_bf16_f32 v77, v78, v79
  v_mfma_f32_16x16x32_bf16 v[252:255], v[40:43], v[104:107], v[252:255]
  ds_write_b64 v118, v[76:77] offset:20576
  ds_read_b128 v[64:67], v121 offset:20480
  ds_read_b128 v[68:71], v121 offset:21632
  v_mfma_f32_16x16x32_bf16 v[252:255], v[44:47], v[108:111], v[252:255]
  s_waitcnt lgkmcnt(0)
  buffer_store_dwordx4 v[64:67], v124, s[16:19], s67 offen offset:0 sc1 nt
  buffer_store_dwordx4 v[68:71], v125, s[16:19], s67 offen offset:0 sc1 nt
  s_barrier
  ds_read_b128 v[48:51], v116 offset:0
  ds_read_b128 v[52:55], v116 offset:1024
  ds_read_b128 v[56:59], v116 offset:2048
  ds_read_b128 v[60:63], v116 offset:3072
  ds_read_b128 v[64:67], v116 offset:4096
  ds_read_b128 v[68:71], v116 offset:5120
  ds_read_b128 v[72:75], v116 offset:6144
  ds_read_b128 v[76:79], v116 offset:7168
  s_nop 3
  s_waitcnt lgkmcnt(4)
  v_pk_add_f32 v[48:49], v[48:49], v[192:193]
  v_pk_add_f32 v[50:51], v[50:51], v[194:195]
  v_pk_mul_f32 v[48:49], v[48:49], v[12:13] op_sel_hi:[1,0]
  v_pk_mul_f32 v[50:51], v[50:51], v[12:13] op_sel_hi:[1,0]
  v_cvt_pk_bf16_f32 v48, v48, v49
  v_cvt_pk_bf16_f32 v49, v50, v51
  ds_write_b64 v119, v[48:49] offset:0
  v_pk_add_f32 v[52:53], v[52:53], v[208:209]
  v_pk_add_f32 v[54:55], v[54:55], v[210:211]
  v_pk_mul_f32 v[52:53], v[52:53], v[12:13] op_sel_hi:[1,0]
  v_pk_mul_f32 v[54:55], v[54:55], v[12:13] op_sel_hi:[1,0]
  v_cvt_pk_bf16_f32 v52, v52, v53
  v_cvt_pk_bf16_f32 v53, v54, v55
  ds_write_b64 v119, v[52:53] offset:32
  v_pk_add_f32 v[56:57], v[56:57], v[224:225]
  v_pk_add_f32 v[58:59], v[58:59], v[226:227]
  v_pk_mul_f32 v[56:57], v[56:57], v[12:13] op_sel_hi:[1,0]
  v_pk_mul_f32 v[58:59], v[58:59], v[12:13] op_sel_hi:[1,0]
  v_cvt_pk_bf16_f32 v56, v56, v57
  v_cvt_pk_bf16_f32 v57, v58, v59
  ds_write_b64 v119, v[56:57] offset:64
  v_pk_add_f32 v[60:61], v[60:61], v[240:241]
  v_pk_add_f32 v[62:63], v[62:63], v[242:243]
  v_pk_mul_f32 v[60:61], v[60:61], v[12:13] op_sel_hi:[1,0]
  v_pk_mul_f32 v[62:63], v[62:63], v[12:13] op_sel_hi:[1,0]
  v_cvt_pk_bf16_f32 v60, v60, v61
  v_cvt_pk_bf16_f32 v61, v62, v63
  ds_write_b64 v119, v[60:61] offset:96
  ds_read_b128 v[16:19], v122 offset:0
  ds_read_b128 v[20:23], v122 offset:1152
  ds_read_b128 v[80:83], v117 offset:0
  ds_read_b128 v[84:87], v117 offset:1024
  ds_read_b128 v[88:91], v117 offset:2048
  ds_read_b128 v[92:95], v117 offset:3072
  s_waitcnt lgkmcnt(10)
  v_pk_add_f32 v[64:65], v[64:65], v[196:197]
  v_pk_add_f32 v[66:67], v[66:67], v[198:199]
  v_pk_mul_f32 v[64:65], v[64:65], v[12:13] op_sel:[0,1] op_sel_hi:[1,1]
  v_pk_mul_f32 v[66:67], v[66:67], v[12:13] op_sel:[0,1] op_sel_hi:[1,1]
  v_cvt_pk_bf16_f32 v64, v64, v65
  v_cvt_pk_bf16_f32 v65, v66, v67
  s_waitcnt lgkmcnt(4)
  buffer_store_dwordx4 v[16:19], v124, s[16:19], s64 offen offset:128 sc1 nt
  buffer_store_dwordx4 v[20:23], v125, s[16:19], s64 offen offset:128 sc1 nt
  ds_write_b64 v119, v[64:65] offset:4096
  v_pk_add_f32 v[68:69], v[68:69], v[212:213]
  v_pk_add_f32 v[70:71], v[70:71], v[214:215]
  v_pk_mul_f32 v[68:69], v[68:69], v[12:13] op_sel:[0,1] op_sel_hi:[1,1]
  v_pk_mul_f32 v[70:71], v[70:71], v[12:13] op_sel:[0,1] op_sel_hi:[1,1]
  v_cvt_pk_bf16_f32 v68, v68, v69
  v_cvt_pk_bf16_f32 v69, v70, v71
  ds_write_b64 v119, v[68:69] offset:4128
  v_pk_add_f32 v[72:73], v[72:73], v[228:229]
  v_pk_add_f32 v[74:75], v[74:75], v[230:231]
  v_pk_mul_f32 v[72:73], v[72:73], v[12:13] op_sel:[0,1] op_sel_hi:[1,1]
  v_pk_mul_f32 v[74:75], v[74:75], v[12:13] op_sel:[0,1] op_sel_hi:[1,1]
  v_cvt_pk_bf16_f32 v72, v72, v73
  v_cvt_pk_bf16_f32 v73, v74, v75
  ds_write_b64 v119, v[72:73] offset:4160
  v_pk_add_f32 v[76:77], v[76:77], v[244:245]
  v_pk_add_f32 v[78:79], v[78:79], v[246:247]
  v_pk_mul_f32 v[76:77], v[76:77], v[12:13] op_sel:[0,1] op_sel_hi:[1,1]
  v_pk_mul_f32 v[78:79], v[78:79], v[12:13] op_sel:[0,1] op_sel_hi:[1,1]
  v_cvt_pk_bf16_f32 v76, v76, v77
  v_cvt_pk_bf16_f32 v77, v78, v79
  ds_write_b64 v119, v[76:77] offset:4192
  ds_read_b128 v[24:27], v122 offset:4096
  ds_read_b128 v[28:31], v122 offset:5248
  ds_read_b128 v[96:99], v117 offset:4096
  ds_read_b128 v[100:103], v117 offset:5120
  ds_read_b128 v[104:107], v117 offset:6144
  ds_read_b128 v[108:111], v117 offset:7168
  s_waitcnt lgkmcnt(10)
  v_pk_add_f32 v[80:81], v[80:81], v[200:201]
  v_pk_add_f32 v[82:83], v[82:83], v[202:203]
  v_pk_mul_f32 v[80:81], v[80:81], v[14:15] op_sel_hi:[1,0]
  v_pk_mul_f32 v[82:83], v[82:83], v[14:15] op_sel_hi:[1,0]
  v_cvt_pk_bf16_f32 v80, v80, v81
  v_cvt_pk_bf16_f32 v81, v82, v83
  s_waitcnt lgkmcnt(4)
  buffer_store_dwordx4 v[24:27], v124, s[16:19], s65 offen offset:128 sc1 nt
  buffer_store_dwordx4 v[28:31], v125, s[16:19], s65 offen offset:128 sc1 nt
  ds_write_b64 v120, v[80:81] offset:0
  v_pk_add_f32 v[84:85], v[84:85], v[216:217]
  v_pk_add_f32 v[86:87], v[86:87], v[218:219]
  v_pk_mul_f32 v[84:85], v[84:85], v[14:15] op_sel_hi:[1,0]
  v_pk_mul_f32 v[86:87], v[86:87], v[14:15] op_sel_hi:[1,0]
  v_cvt_pk_bf16_f32 v84, v84, v85
  v_cvt_pk_bf16_f32 v85, v86, v87
  ds_write_b64 v120, v[84:85] offset:32
  v_pk_add_f32 v[88:89], v[88:89], v[232:233]
  v_pk_add_f32 v[90:91], v[90:91], v[234:235]
  v_pk_mul_f32 v[88:89], v[88:89], v[14:15] op_sel_hi:[1,0]
  v_pk_mul_f32 v[90:91], v[90:91], v[14:15] op_sel_hi:[1,0]
  v_cvt_pk_bf16_f32 v88, v88, v89
  v_cvt_pk_bf16_f32 v89, v90, v91
  ds_write_b64 v120, v[88:89] offset:64
  v_pk_add_f32 v[92:93], v[92:93], v[248:249]
  v_pk_add_f32 v[94:95], v[94:95], v[250:251]
  v_pk_mul_f32 v[92:93], v[92:93], v[14:15] op_sel_hi:[1,0]
  v_pk_mul_f32 v[94:95], v[94:95], v[14:15] op_sel_hi:[1,0]
  v_cvt_pk_bf16_f32 v92, v92, v93
  v_cvt_pk_bf16_f32 v93, v94, v95
  ds_write_b64 v120, v[92:93] offset:96
  ds_read_b128 v[32:35], v123 offset:0
  ds_read_b128 v[36:39], v123 offset:1152
  s_waitcnt lgkmcnt(6)
  v_pk_add_f32 v[96:97], v[96:97], v[204:205]
  v_pk_add_f32 v[98:99], v[98:99], v[206:207]
  v_pk_mul_f32 v[96:97], v[96:97], v[14:15] op_sel:[0,1] op_sel_hi:[1,1]
  v_pk_mul_f32 v[98:99], v[98:99], v[14:15] op_sel:[0,1] op_sel_hi:[1,1]
  v_cvt_pk_bf16_f32 v96, v96, v97
  v_cvt_pk_bf16_f32 v97, v98, v99
  s_waitcnt lgkmcnt(0)
  buffer_store_dwordx4 v[32:35], v124, s[16:19], s66 offen offset:128 sc1 nt
  buffer_store_dwordx4 v[36:39], v125, s[16:19], s66 offen offset:128 sc1 nt
  ds_write_b64 v120, v[96:97] offset:4096
  v_pk_add_f32 v[100:101], v[100:101], v[220:221]
  v_pk_add_f32 v[102:103], v[102:103], v[222:223]
  v_pk_mul_f32 v[100:101], v[100:101], v[14:15] op_sel:[0,1] op_sel_hi:[1,1]
  v_pk_mul_f32 v[102:103], v[102:103], v[14:15] op_sel:[0,1] op_sel_hi:[1,1]
  v_cvt_pk_bf16_f32 v100, v100, v101
  v_cvt_pk_bf16_f32 v101, v102, v103
  ds_write_b64 v120, v[100:101] offset:4128
  v_pk_add_f32 v[104:105], v[104:105], v[236:237]
  v_pk_add_f32 v[106:107], v[106:107], v[238:239]
  v_pk_mul_f32 v[104:105], v[104:105], v[14:15] op_sel:[0,1] op_sel_hi:[1,1]
  v_pk_mul_f32 v[106:107], v[106:107], v[14:15] op_sel:[0,1] op_sel_hi:[1,1]
  v_cvt_pk_bf16_f32 v104, v104, v105
  v_cvt_pk_bf16_f32 v105, v106, v107
  ds_write_b64 v120, v[104:105] offset:4160
  v_pk_add_f32 v[108:109], v[108:109], v[252:253]
  v_pk_add_f32 v[110:111], v[110:111], v[254:255]
  v_pk_mul_f32 v[108:109], v[108:109], v[14:15] op_sel:[0,1] op_sel_hi:[1,1]
  v_pk_mul_f32 v[110:111], v[110:111], v[14:15] op_sel:[0,1] op_sel_hi:[1,1]
  v_cvt_pk_bf16_f32 v108, v108, v109
  v_cvt_pk_bf16_f32 v109, v110, v111
  ds_write_b64 v120, v[108:109] offset:4192
  ds_read_b128 v[40:43], v123 offset:4096
  ds_read_b128 v[44:47], v123 offset:5248
  s_waitcnt lgkmcnt(0)
  buffer_store_dwordx4 v[40:43], v124, s[16:19], s67 offen offset:128 sc1 nt
  buffer_store_dwordx4 v[44:47], v125, s[16:19], s67 offen offset:128 sc1 nt
  s_cmp_eq_u32 s27, 1
  s_cbranch_scc1 L_end
  s_cmp_eq_u32 s31, 0
  s_cbranch_scc1 L_end
L_fastend:
  s_mov_b32 s27, 1
  s_mov_b32 s10, 0x1000800
  s_waitcnt vmcnt(0) lgkmcnt(0)
  s_barrier
  v_and_b32 v11, 63, v0
  s_lshl_b32 s78, s23, 20
  s_lshl_b32 s79, s22, 19
  s_add_u32 s78, s78, s79
  v_bfe_u32 v4, v11, 2, 3
  v_lshlrev_b32 v4, 9, v4
  v_lshrrev_b32 v8, 5, v11
  v_lshl_add_u32 v4, v8, 6, v4
  v_and_b32 v8, 3, v11
  v_lshrrev_b32 v9, 3, v11
  v_and_b32 v9, 2, v9
  v_xor_b32 v8, v8, v9
  v_lshl_add_u32 v4, v8, 4, v4
  s_lshl_b32 s79, s21, 8
  s_add_u32 s79, s79, s78
  v_add_u32 v4, s79, v4
  s_lshl_b32 s78, s23, 20
  s_lshl_b32 s79, s22, 19
  s_add_u32 s78, s78, s79
  v_bfe_u32 v5, v11, 2, 2
  v_lshlrev_b32 v5, 10, v5
  v_bfe_u32 v8, v11, 4, 1
  v_lshl_add_u32 v5, v8, 9, v5
  v_lshlrev_b32 v8, 1, v8
  v_and_b32 v9, 3, v11
  v_xor_b32 v9, v9, v8
  v_lshl_add_u32 v5, v9, 4, v5
  v_lshrrev_b32 v8, 5, v11
  v_lshl_add_u32 v5, v8, 6, v5
  s_lshl_b32 s79, s21, 14
  s_add_u32 s79, s79, s78
  v_add_u32 v5, s79, v5
  v_bfe_u32 v1, v11, 3, 1
  v_lshlrev_b32 v1, 10, v1
  v_and_b32 v8, 7, v11
  v_lshl_add_u32 v1, v8, 6, v1
  v_lshrrev_b32 v8, 4, v11
  v_lshrrev_b32 v9, 1, v11
  v_and_b32 v9, 2, v9
  v_xor_b32 v8, v8, v9
  v_lshl_add_u32 v1, v8, 4, v1
  s_lshl_b32 s78, s22, 16
  v_lshrrev_b32 v2, 5, v11
  v_lshlrev_b32 v2, 10, v2
  v_bfe_u32 v8, v11, 2, 1
  v_lshl_add_u32 v2, v8, 8, v2
  v_bfe_u32 v9, v11, 4, 1
  v_lshl_add_u32 v2, v9, 7, v2
  v_bfe_u32 v9, v11, 3, 1
  v_lshl_add_u32 v2, v9, 6, v2
  v_bfe_u32 v9, v11, 1, 1
  v_lshlrev_b32 v8, 1, v8
  v_xor_b32 v9, v9, v8
  v_lshl_add_u32 v2, v9, 4, v2
  v_and_b32 v9, 1, v11
  v_lshl_add_u32 v2, v9, 3, v2
  v_add_u32 v2, s78, v2
  v_xor_b32 v3, 32, v2
  s_lshl_b32 s76, s22, 16
  v_add_u32 v1, s76, v1
  v_and_b32 v7, 63, v0
  v_mov_b32 v48, 0xff800000
  v_mov_b32 v49, 0xff800000
  v_mov_b32 v50, 0xff800000
  v_mov_b32 v51, 0xff800000
  s_mov_b32 s26, 16
L_p1:
  s_add_u32 m0, s25, 0
  s_nop 0
  buffer_load_dwordx4 v4, s[8:11], s32 offen offset:0 lds
  buffer_load_dwordx4 v4, s[8:11], s33 offen offset:1024 lds
  buffer_load_dwordx4 v4, s[8:11], s34 offen offset:2048 lds
  buffer_load_dwordx4 v4, s[8:11], s35 offen offset:3072 lds
  s_add_u32 m0, s25, 16384
  s_nop 0
  buffer_load_dwordx4 v4, s[8:11], s36 offen offset:0 lds
  buffer_load_dwordx4 v4, s[8:11], s37 offen offset:1024 lds
  buffer_load_dwordx4 v4, s[8:11], s38 offen offset:2048 lds
  buffer_load_dwordx4 v4, s[8:11], s39 offen offset:3072 lds
  s_add_u32 m0, s25, 32768
  s_nop 0
  buffer_load_dwordx4 v4, s[8:11], s40 offen offset:0 lds
  buffer_load_dwordx4 v4, s[8:11], s41 offen offset:1024 lds
  buffer_load_dwordx4 v4, s[8:11], s42 offen offset:2048 lds
  buffer_load_dwordx4 v4, s[8:11], s43 offen offset:3072 lds
  s_add_u32 m0, s25, 49152
  s_nop 0
  buffer_load_dwordx4 v4, s[8:11], s44 offen offset:0 lds
  buffer_load_dwordx4 v4, s[8:11], s45 offen offset:1024 lds
  buffer_load_dwordx4 v4, s[8:11], s46 offen offset:2048 lds
  buffer_load_dwordx4 v4, s[8:11], s47 offen offset:3072 lds
  v_add_u32 v4, 0x8000, v4
  s_waitcnt vmcnt(0)
  s_barrier
  ds_read_b128 v[16:19], v1 offset:0
  ds_read_b128 v[20:23], v1 offset:512
  ds_read_b128 v[24:27], v1 offset:2048
  ds_read_b128 v[28:31], v1 offset:2560
  ds_read_b128 v[32:35], v1 offset:4096
  ds_read_b128 v[36:39], v1 offset:4608
  ds_read_b128 v[40:43], v1 offset:6144
  ds_read_b128 v[44:47], v1 offset:6656
  s_waitcnt lgkmcnt(0)
  v_mfma_f32_16x16x32_bf16 v[112:115], v[16:19], a[0:3], 0
  v_mfma_f32_16x16x32_bf16 v[112:115], v[20:23], a[4:7], v[112:115]
  v_mfma_f32_16x16x32_bf16 v[112:115], v[24:27], a[8:11], v[112:115]
  v_mfma_f32_16x16x32_bf16 v[112:115], v[28:31], a[12:15], v[112:115]
  v_mfma_f32_16x16x32_bf16 v[112:115], v[32:35], a[16:19], v[112:115]
  v_mfma_f32_16x16x32_bf16 v[112:115], v[36:39], a[20:23], v[112:115]
  v_mfma_f32_16x16x32_bf16 v[112:115], v[40:43], a[24:27], v[112:115]
  v_mfma_f32_16x16x32_bf16 v[112:115], v[44:47], a[28:31], v[112:115]
  v_mfma_f32_16x16x32_bf16 v[116:119], v[16:19], a[32:35], 0
  v_mfma_f32_16x16x32_bf16 v[116:119], v[20:23], a[36:39], v[116:119]
  v_mfma_f32_16x16x32_bf16 v[116:119], v[24:27], a[40:43], v[116:119]
  v_mfma_f32_16x16x32_bf16 v[116:119], v[28:31], a[44:47], v[116:119]
  v_mfma_f32_16x16x32_bf16 v[116:119], v[32:35], a[48:51], v[116:119]
  v_mfma_f32_16x16x32_bf16 v[116:119], v[36:39], a[52:55], v[116:119]
  v_mfma_f32_16x16x32_bf16 v[116:119], v[40:43], a[56:59], v[116:119]
  v_mfma_f32_16x16x32_bf16 v[116:119], v[44:47], a[60:63], v[116:119]
  v_mfma_f32_16x16x32_bf16 v[120:123], v[16:19], a[64:67], 0
  v_mfma_f32_16x16x32_bf16 v[120:123], v[20:23], a[68:71], v[120:123]
  v_mfma_f32_16x16x32_bf16 v[120:123], v[24:27], a[72:75], v[120:123]
  v_mfma_f32_16x16x32_bf16 v[120:123], v[28:31], a[76:79], v[120:123]
  v_mfma_f32_16x16x32_bf16 v[120:123], v[32:35], a[80:83], v[120:123]
  v_mfma_f32_16x16x32_bf16 v[120:123], v[36:39], a[84:87], v[120:123]
  v_mfma_f32_16x16x32_bf16 v[120:123], v[40:43], a[88:91], v[120:123]
  v_mfma_f32_16x16x32_bf16 v[120:123], v[44:47], a[92:95], v[120:123]
  v_mfma_f32_16x16x32_bf16 v[124:127], v[16:19], a[96:99], 0
  v_mfma_f32_16x16x32_bf16 v[124:127], v[20:23], a[100:103], v[124:127]
  v_mfma_f32_16x16x32_bf16 v[124:127], v[24:27], a[104:107], v[124:127]
  v_mfma_f32_16x16x32_bf16 v[124:127], v[28:31], a[108:111], v[124:127]
  v_mfma_f32_16x16x32_bf16 v[124:127], v[32:35], a[112:115], v[124:127]
  v_mfma_f32_16x16x32_bf16 v[124:127], v[36:39], a[116:119], v[124:127]
  v_mfma_f32_16x16x32_bf16 v[124:127], v[40:43], a[120:123], v[124:127]
  v_mfma_f32_16x16x32_bf16 v[124:127], v[44:47], a[124:127], v[124:127]
  s_nop 7
  s_nop 3
  v_max3_f32 v48, v48, v112, v113
  v_max3_f32 v48, v48, v114, v115
  v_max3_f32 v49, v49, v116, v117
  v_max3_f32 v49, v49, v118, v119
  v_max3_f32 v50, v50, v120, v121
  v_max3_f32 v50, v50, v122, v123
  v_max3_f32 v51, v51, v124, v125
  v_max3_f32 v51, v51, v126, v127
  ds_read_b128 v[16:19], v1 offset:16384
  ds_read_b128 v[20:23], v1 offset:16896
  ds_read_b128 v[24:27], v1 offset:18432
  ds_read_b128 v[28:31], v1 offset:18944
  ds_read_b128 v[32:35], v1 offset:20480
  ds_read_b128 v[36:39], v1 offset:20992
  ds_read_b128 v[40:43], v1 offset:22528
  ds_read_b128 v[44:47], v1 offset:23040
  s_waitcnt lgkmcnt(0)
  v_mfma_f32_16x16x32_bf16 v[112:115], v[16:19], a[0:3], 0
  v_mfma_f32_16x16x32_bf16 v[112:115], v[20:23], a[4:7], v[112:115]
  v_mfma_f32_16x16x32_bf16 v[112:115], v[24:27], a[8:11], v[112:115]
  v_mfma_f32_16x16x32_bf16 v[112:115], v[28:31], a[12:15], v[112:115]
  v_mfma_f32_16x16x32_bf16 v[112:115], v[32:35], a[16:19], v[112:115]
  v_mfma_f32_16x16x32_bf16 v[112:115], v[36:39], a[20:23], v[112:115]
  v_mfma_f32_16x16x32_bf16 v[112:115], v[40:43], a[24:27], v[112:115]
  v_mfma_f32_16x16x32_bf16 v[112:115], v[44:47], a[28:31], v[112:115]
  v_mfma_f32_16x16x32_bf16 v[116:119], v[16:19], a[32:35], 0
  v_mfma_f32_16x16x32_bf16 v[116:119], v[20:23], a[36:39], v[116:119]
  v_mfma_f32_16x16x32_bf16 v[116:119], v[24:27], a[40:43], v[116:119]
  v_mfma_f32_16x16x32_bf16 v[116:119], v[28:31], a[44:47], v[116:119]
  v_mfma_f32_16x16x32_bf16 v[116:119], v[32:35], a[48:51], v[116:119]
  v_mfma_f32_16x16x32_bf16 v[116:119], v[36:39], a[52:55], v[116:119]
  v_mfma_f32_16x16x32_bf16 v[116:119], v[40:43], a[56:59], v[116:119]
  v_mfma_f32_16x16x32_bf16 v[116:119], v[44:47], a[60:63], v[116:119]
  v_mfma_f32_16x16x32_bf16 v[120:123], v[16:19], a[64:67], 0
  v_mfma_f32_16x16x32_bf16 v[120:123], v[20:23], a[68:71], v[120:123]
  v_mfma_f32_16x16x32_bf16 v[120:123], v[24:27], a[72:75], v[120:123]
  v_mfma_f32_16x16x32_bf16 v[120:123], v[28:31], a[76:79], v[120:123]
  v_mfma_f32_16x16x32_bf16 v[120:123], v[32:35], a[80:83], v[120:123]
  v_mfma_f32_16x16x32_bf16 v[120:123], v[36:39], a[84:87], v[120:123]
  v_mfma_f32_16x16x32_bf16 v[120:123], v[40:43], a[88:91], v[120:123]
  v_mfma_f32_16x16x32_bf16 v[120:123], v[44:47], a[92:95], v[120:123]
  v_mfma_f32_16x16x32_bf16 v[124:127], v[16:19], a[96:99], 0
  v_mfma_f32_16x16x32_bf16 v[124:127], v[20:23], a[100:103], v[124:127]
  v_mfma_f32_16x16x32_bf16 v[124:127], v[24:27], a[104:107], v[124:127]
  v_mfma_f32_16x16x32_bf16 v[124:127], v[28:31], a[108:111], v[124:127]
  v_mfma_f32_16x16x32_bf16 v[124:127], v[32:35], a[112:115], v[124:127]
  v_mfma_f32_16x16x32_bf16 v[124:127], v[36:39], a[116:119], v[124:127]
  v_mfma_f32_16x16x32_bf16 v[124:127], v[40:43], a[120:123], v[124:127]
  v_mfma_f32_16x16x32_bf16 v[124:127], v[44:47], a[124:127], v[124:127]
  s_nop 7
  s_nop 3
  v_max3_f32 v48, v48, v112, v113
  v_max3_f32 v48, v48, v114, v115
  v_max3_f32 v49, v49, v116, v117
  v_max3_f32 v49, v49, v118, v119
  v_max3_f32 v50, v50, v120, v121
  v_max3_f32 v50, v50, v122, v123
  v_max3_f32 v51, v51, v124, v125
  v_max3_f32 v51, v51, v126, v127
  ds_read_b128 v[16:19], v1 offset:32768
  ds_read_b128 v[20:23], v1 offset:33280
  ds_read_b128 v[24:27], v1 offset:34816
  ds_read_b128 v[28:31], v1 offset:35328
  ds_read_b128 v[32:35], v1 offset:36864
  ds_read_b128 v[36:39], v1 offset:37376
  ds_read_b128 v[40:43], v1 offset:38912
  ds_read_b128 v[44:47], v1 offset:39424
  s_waitcnt lgkmcnt(0)
  v_mfma_f32_16x16x32_bf16 v[112:115], v[16:19], a[0:3], 0
  v_mfma_f32_16x16x32_bf16 v[112:115], v[20:23], a[4:7], v[112:115]
  v_mfma_f32_16x16x32_bf16 v[112:115], v[24:27], a[8:11], v[112:115]
  v_mfma_f32_16x16x32_bf16 v[112:115], v[28:31], a[12:15], v[112:115]
  v_mfma_f32_16x16x32_bf16 v[112:115], v[32:35], a[16:19], v[112:115]
  v_mfma_f32_16x16x32_bf16 v[112:115], v[36:39], a[20:23], v[112:115]
  v_mfma_f32_16x16x32_bf16 v[112:115], v[40:43], a[24:27], v[112:115]
  v_mfma_f32_16x16x32_bf16 v[112:115], v[44:47], a[28:31], v[112:115]
  v_mfma_f32_16x16x32_bf16 v[116:119], v[16:19], a[32:35], 0
  v_mfma_f32_16x16x32_bf16 v[116:119], v[20:23], a[36:39], v[116:119]
  v_mfma_f32_16x16x32_bf16 v[116:119], v[24:27], a[40:43], v[116:119]
  v_mfma_f32_16x16x32_bf16 v[116:119], v[28:31], a[44:47], v[116:119]
  v_mfma_f32_16x16x32_bf16 v[116:119], v[32:35], a[48:51], v[116:119]
  v_mfma_f32_16x16x32_bf16 v[116:119], v[36:39], a[52:55], v[116:119]
  v_mfma_f32_16x16x32_bf16 v[116:119], v[40:43], a[56:59], v[116:119]
  v_mfma_f32_16x16x32_bf16 v[116:119], v[44:47], a[60:63], v[116:119]
  v_mfma_f32_16x16x32_bf16 v[120:123], v[16:19], a[64:67], 0
  v_mfma_f32_16x16x32_bf16 v[120:123], v[20:23], a[68:71], v[120:123]
  v_mfma_f32_16x16x32_bf16 v[120:123], v[24:27], a[72:75], v[120:123]
  v_mfma_f32_16x16x32_bf16 v[120:123], v[28:31], a[76:79], v[120:123]
  v_mfma_f32_16x16x32_bf16 v[120:123], v[32:35], a[80:83], v[120:123]
  v_mfma_f32_16x16x32_bf16 v[120:123], v[36:39], a[84:87], v[120:123]
  v_mfma_f32_16x16x32_bf16 v[120:123], v[40:43], a[88:91], v[120:123]
  v_mfma_f32_16x16x32_bf16 v[120:123], v[44:47], a[92:95], v[120:123]
  v_mfma_f32_16x16x32_bf16 v[124:127], v[16:19], a[96:99], 0
  v_mfma_f32_16x16x32_bf16 v[124:127], v[20:23], a[100:103], v[124:127]
  v_mfma_f32_16x16x32_bf16 v[124:127], v[24:27], a[104:107], v[124:127]
  v_mfma_f32_16x16x32_bf16 v[124:127], v[28:31], a[108:111], v[124:127]
  v_mfma_f32_16x16x32_bf16 v[124:127], v[32:35], a[112:115], v[124:127]
  v_mfma_f32_16x16x32_bf16 v[124:127], v[36:39], a[116:119], v[124:127]
  v_mfma_f32_16x16x32_bf16 v[124:127], v[40:43], a[120:123], v[124:127]
  v_mfma_f32_16x16x32_bf16 v[124:127], v[44:47], a[124:127], v[124:127]
  s_nop 7
  s_nop 3
  v_max3_f32 v48, v48, v112, v113
  v_max3_f32 v48, v48, v114, v115
  v_max3_f32 v49, v49, v116, v117
  v_max3_f32 v49, v49, v118, v119
  v_max3_f32 v50, v50, v120, v121
  v_max3_f32 v50, v50, v122, v123
  v_max3_f32 v51, v51, v124, v125
  v_max3_f32 v51, v51, v126, v127
  ds_read_b128 v[16:19], v1 offset:49152
  ds_read_b128 v[20:23], v1 offset:49664
  ds_read_b128 v[24:27], v1 offset:51200
  ds_read_b128 v[28:31], v1 offset:51712
  ds_read_b128 v[32:35], v1 offset:53248
  ds_read_b128 v[36:39], v1 offset:53760
  ds_read_b128 v[40:43], v1 offset:55296
  ds_read_b128 v[44:47], v1 offset:55808
  s_waitcnt lgkmcnt(0)
  v_mfma_f32_16x16x32_bf16 v[112:115], v[16:19], a[0:3], 0
  v_mfma_f32_16x16x32_bf16 v[112:115], v[20:23], a[4:7], v[112:115]
  v_mfma_f32_16x16x32_bf16 v[112:115], v[24:27], a[8:11], v[112:115]
  v_mfma_f32_16x16x32_bf16 v[112:115], v[28:31], a[12:15], v[112:115]
  v_mfma_f32_16x16x32_bf16 v[112:115], v[32:35], a[16:19], v[112:115]
  v_mfma_f32_16x16x32_bf16 v[112:115], v[36:39], a[20:23], v[112:115]
  v_mfma_f32_16x16x32_bf16 v[112:115], v[40:43], a[24:27], v[112:115]
  v_mfma_f32_16x16x32_bf16 v[112:115], v[44:47], a[28:31], v[112:115]
  v_mfma_f32_16x16x32_bf16 v[116:119], v[16:19], a[32:35], 0
  v_mfma_f32_16x16x32_bf16 v[116:119], v[20:23], a[36:39], v[116:119]
  v_mfma_f32_16x16x32_bf16 v[116:119], v[24:27], a[40:43], v[116:119]
  v_mfma_f32_16x16x32_bf16 v[116:119], v[28:31], a[44:47], v[116:119]
  v_mfma_f32_16x16x32_bf16 v[116:119], v[32:35], a[48:51], v[116:119]
  v_mfma_f32_16x16x32_bf16 v[116:119], v[36:39], a[52:55], v[116:119]
  v_mfma_f32_16x16x32_bf16 v[116:119], v[40:43], a[56:59], v[116:119]
  v_mfma_f32_16x16x32_bf16 v[116:119], v[44:47], a[60:63], v[116:119]
  v_mfma_f32_16x16x32_bf16 v[120:123], v[16:19], a[64:67], 0
  v_mfma_f32_16x16x32_bf16 v[120:123], v[20:23], a[68:71], v[120:123]
  v_mfma_f32_16x16x32_bf16 v[120:123], v[24:27], a[72:75], v[120:123]
  v_mfma_f32_16x16x32_bf16 v[120:123], v[28:31], a[76:79], v[120:123]
  v_mfma_f32_16x16x32_bf16 v[120:123], v[32:35], a[80:83], v[120:123]
  v_mfma_f32_16x16x32_bf16 v[120:123], v[36:39], a[84:87], v[120:123]
  v_mfma_f32_16x16x32_bf16 v[120:123], v[40:43], a[88:91], v[120:123]
  v_mfma_f32_16x16x32_bf16 v[120:123], v[44:47], a[92:95], v[120:123]
  v_mfma_f32_16x16x32_bf16 v[124:127], v[16:19], a[96:99], 0
  v_mfma_f32_16x16x32_bf16 v[124:127], v[20:23], a[100:103], v[124:127]
  v_mfma_f32_16x16x32_bf16 v[124:127], v[24:27], a[104:107], v[124:127]
  v_mfma_f32_16x16x32_bf16 v[124:127], v[28:31], a[108:111], v[124:127]
  v_mfma_f32_16x16x32_bf16 v[124:127], v[32:35], a[112:115], v[124:127]
  v_mfma_f32_16x16x32_bf16 v[124:127], v[36:39], a[116:119], v[124:127]
  v_mfma_f32_16x16x32_bf16 v[124:127], v[40:43], a[120:123], v[124:127]
  v_mfma_f32_16x16x32_bf16 v[124:127], v[44:47], a[124:127], v[124:127]
  s_nop 7
  s_nop 3
  v_max3_f32 v48, v48, v112, v113
  v_max3_f32 v48, v48, v114, v115
  v_max3_f32 v49, v49, v116, v117
  v_max3_f32 v49, v49, v118, v119
  v_max3_f32 v50, v50, v120, v121
  v_max3_f32 v50, v50, v122, v123
  v_max3_f32 v51, v51, v124, v125
  v_max3_f32 v51, v51, v126, v127
  s_barrier
  s_sub_u32 s26, s26, 1
  s_cmp_lg_u32 s26, 0
  s_cbranch_scc1 L_p1
  v_and_b32 v6, 15, v7
  v_lshlrev_b32 v6, 5, v6
  s_lshl_b32 s76, s21, 11
  s_add_u32 s76, s76, 131072
  v_add_u32 v6, s76, v6
  v_lshrrev_b32 v8, 4, v7
  s_lshl_b32 s77, s22, 4
  v_lshl_add_u32 v8, v8, 2, v6
  v_add_u32 v8, s77, v8
  ds_write_b32 v8, v48 offset:0
  ds_write_b32 v8, v49 offset:512
  ds_write_b32 v8, v50 offset:1024
  ds_write_b32 v8, v51 offset:1536
  s_waitcnt lgkmcnt(0)
  s_barrier
  ds_read_b128 v[16:19], v6 offset:0
  ds_read_b128 v[20:23], v6 offset:16
  ds_read_b128 v[24:27], v6 offset:512
  ds_read_b128 v[28:31], v6 offset:528
  ds_read_b128 v[32:35], v6 offset:1024
  ds_read_b128 v[36:39], v6 offset:1040
  ds_read_b128 v[40:43], v6 offset:1536
  ds_read_b128 v[44:47], v6 offset:1552
  s_waitcnt lgkmcnt(0)
  v_max3_f32 v16, v16, v17, v18
  v_max3_f32 v16, v16, v19, v20
  v_max3_f32 v16, v16, v21, v22
  v_max_f32 v48, v16, v23
  v_max3_f32 v24, v24, v25, v26
  v_max3_f32 v24, v24, v27, v28
  v_max3_f32 v24, v24, v29, v30
  v_max_f32 v49, v24, v31
  v_max3_f32 v32, v32, v33, v34
  v_max3_f32 v32, v32, v35, v36
  v_max3_f32 v32, v32, v37, v38
  v_max_f32 v50, v32, v39
  v_max3_f32 v40, v40, v41, v42
  v_max3_f32 v40, v40, v43, v44
  v_max3_f32 v40, v40, v45, v46
  v_max_f32 v51, v40, v47
  v_and_b32 v11, 63, v0
  s_lshl_b32 s78, s23, 20
  s_lshl_b32 s79, s22, 19
  s_add_u32 s78, s78, s79
  v_bfe_u32 v4, v11, 2, 3
  v_lshlrev_b32 v4, 9, v4
  v_lshrrev_b32 v8, 5, v11
  v_lshl_add_u32 v4, v8, 6, v4
  v_and_b32 v8, 3, v11
  v_lshrrev_b32 v9, 3, v11
  v_and_b32 v9, 2, v9
  v_xor_b32 v8, v8, v9
  v_lshl_add_u32 v4, v8, 4, v4
  s_lshl_b32 s79, s21, 8
  s_add_u32 s79, s79, s78
  v_add_u32 v4, s79, v4
  s_lshl_b32 s78, s23, 20
  s_lshl_b32 s79, s22, 19
  s_add_u32 s78, s78, s79
  v_bfe_u32 v5, v11, 2, 2
  v_lshlrev_b32 v5, 10, v5
  v_bfe_u32 v8, v11, 4, 1
  v_lshl_add_u32 v5, v8, 9, v5
  v_lshlrev_b32 v8, 1, v8
  v_and_b32 v9, 3, v11
  v_xor_b32 v9, v9, v8
  v_lshl_add_u32 v5, v9, 4, v5
  v_lshrrev_b32 v8, 5, v11
  v_lshl_add_u32 v5, v8, 6, v5
  s_lshl_b32 s79, s21, 14
  s_add_u32 s79, s79, s78
  v_add_u32 v5, s79, v5
  v_bfe_u32 v1, v11, 3, 1
  v_lshlrev_b32 v1, 10, v1
  v_and_b32 v8, 7, v11
  v_lshl_add_u32 v1, v8, 6, v1
  v_lshrrev_b32 v8, 4, v11
  v_lshrrev_b32 v9, 1, v11
  v_and_b32 v9, 2, v9
  v_xor_b32 v8, v8, v9
  v_lshl_add_u32 v1, v8, 4, v1
  s_lshl_b32 s78, s22, 16
  v_lshrrev_b32 v2, 5, v11
  v_lshlrev_b32 v2, 10, v2
  v_bfe_u32 v8, v11, 2, 1
  v_lshl_add_u32 v2, v8, 8, v2
  v_bfe_u32 v9, v11, 4, 1
  v_lshl_add_u32 v2, v9, 7, v2
  v_bfe_u32 v9, v11, 3, 1
  v_lshl_add_u32 v2, v9, 6, v2
  v_bfe_u32 v9, v11, 1, 1
  v_lshlrev_b32 v8, 1, v8
  v_xor_b32 v9, v9, v8
  v_lshl_add_u32 v2, v9, 4, v2
  v_and_b32 v9, 1, v11
  v_lshl_add_u32 v2, v9, 3, v2
  v_add_u32 v2, s78, v2
  v_xor_b32 v3, 32, v2
  s_lshl_b32 s76, s22, 16
  v_add_u32 v1, s76, v1
  v_mov_b32 v128, 0
  v_mov_b32 v129, 0
  v_mov_b32 v130, 0
  v_mov_b32 v131, 0
  v_mov_b32 v132, 0
  v_mov_b32 v133, 0
  v_mov_b32 v134, 0
  v_mov_b32 v135, 0
  v_mov_b32 v136, 0
  v_mov_b32 v137, 0
  v_mov_b32 v138, 0
  v_mov_b32 v139, 0
  v_mov_b32 v140, 0
  v_mov_b32 v141, 0
  v_mov_b32 v142, 0
  v_mov_b32 v143, 0
  v_mov_b32 v144, 0
  v_mov_b32 v145, 0
  v_mov_b32 v146, 0
  v_mov_b32 v147, 0
  v_mov_b32 v148, 0
  v_mov_b32 v149, 0
  v_mov_b32 v150, 0
  v_mov_b32 v151, 0
  v_mov_b32 v152, 0
  v_mov_b32 v153, 0
  v_mov_b32 v154, 0
  v_mov_b32 v155, 0
  v_mov_b32 v156, 0
  v_mov_b32 v157, 0
  v_mov_b32 v158, 0
  v_mov_b32 v159, 0
  v_mov_b32 v160, 0
  v_mov_b32 v161, 0
  v_mov_b32 v162, 0
  v_mov_b32 v163, 0
  v_mov_b32 v164, 0
  v_mov_b32 v165, 0
  v_mov_b32 v166, 0
  v_mov_b32 v167, 0
  v_mov_b32 v168, 0
  v_mov_b32 v169, 0
  v_mov_b32 v170, 0
  v_mov_b32 v171, 0
  v_mov_b32 v172, 0
  v_mov_b32 v173, 0
  v_mov_b32 v174, 0
  v_mov_b32 v175, 0
  v_mov_b32 v176, 0
  v_mov_b32 v177, 0
  v_mov_b32 v178, 0
  v_mov_b32 v179, 0
  v_mov_b32 v180, 0
  v_mov_b32 v181, 0
  v_mov_b32 v182, 0
  v_mov_b32 v183, 0
  v_mov_b32 v184, 0
  v_mov_b32 v185, 0
  v_mov_b32 v186, 0
  v_mov_b32 v187, 0
  v_mov_b32 v188, 0
  v_mov_b32 v189, 0
  v_mov_b32 v190, 0
  v_mov_b32 v191, 0
  v_mov_b32 v192, 0
  v_mov_b32 v193, 0
  v_mov_b32 v194, 0
  v_mov_b32 v195, 0
  v_mov_b32 v196, 0
  v_mov_b32 v197, 0
  v_mov_b32 v198, 0
  v_mov_b32 v199, 0
  v_mov_b32 v200, 0
  v_mov_b32 v201, 0
  v_mov_b32 v202, 0
  v_mov_b32 v203, 0
  v_mov_b32 v204, 0
  v_mov_b32 v205, 0
  v_mov_b32 v206, 0
  v_mov_b32 v207, 0
  v_mov_b32 v208, 0
  v_mov_b32 v209, 0
  v_mov_b32 v210, 0
  v_mov_b32 v211, 0
  v_mov_b32 v212, 0
  v_mov_b32 v213, 0
  v_mov_b32 v214, 0
  v_mov_b32 v215, 0
  v_mov_b32 v216, 0
  v_mov_b32 v217, 0
  v_mov_b32 v218, 0
  v_mov_b32 v219, 0
  v_mov_b32 v220, 0
  v_mov_b32 v221, 0
  v_mov_b32 v222, 0
  v_mov_b32 v223, 0
  v_mov_b32 v224, 0
  v_mov_b32 v225, 0
  v_mov_b32 v226, 0
  v_mov_b32 v227, 0
  v_mov_b32 v228, 0
  v_mov_b32 v229, 0
  v_mov_b32 v230, 0
  v_mov_b32 v231, 0
  v_mov_b32 v232, 0
  v_mov_b32 v233, 0
  v_mov_b32 v234, 0
  v_mov_b32 v235, 0
  v_mov_b32 v236, 0
  v_mov_b32 v237, 0
  v_mov_b32 v238, 0
  v_mov_b32 v239, 0
  v_mov_b32 v240, 0
  v_mov_b32 v241, 0
  v_mov_b32 v242, 0
  v_mov_b32 v243, 0
  v_mov_b32 v244, 0
  v_mov_b32 v245, 0
  v_mov_b32 v246, 0
  v_mov_b32 v247, 0
  v_mov_b32 v248, 0
  v_mov_b32 v249, 0
  v_mov_b32 v250, 0
  v_mov_b32 v251, 0
  v_mov_b32 v252, 0
  v_mov_b32 v253, 0
  v_mov_b32 v254, 0
  v_mov_b32 v255, 0
  v_accvgpr_write_b32 a128, 0
  v_accvgpr_write_b32 a129, 0
  v_accvgpr_write_b32 a130, 0
  v_accvgpr_write_b32 a131, 0
  v_accvgpr_write_b32 a132, 0
  v_accvgpr_write_b32 a133, 0
  v_accvgpr_write_b32 a134, 0
  v_accvgpr_write_b32 a135, 0
  v_accvgpr_write_b32 a136, 0
  v_accvgpr_write_b32 a137, 0
  v_accvgpr_write_b32 a138, 0
  v_accvgpr_write_b32 a139, 0
  v_accvgpr_write_b32 a140, 0
  v_accvgpr_write_b32 a141, 0
  v_accvgpr_write_b32 a142, 0
  v_accvgpr_write_b32 a143, 0
  v_accvgpr_write_b32 a144, 0
  v_accvgpr_write_b32 a145, 0
  v_accvgpr_write_b32 a146, 0
  v_accvgpr_write_b32 a147, 0
  v_accvgpr_write_b32 a148, 0
  v_accvgpr_write_b32 a149, 0
  v_accvgpr_write_b32 a150, 0
  v_accvgpr_write_b32 a151, 0
  v_accvgpr_write_b32 a152, 0
  v_accvgpr_write_b32 a153, 0
  v_accvgpr_write_b32 a154, 0
  v_accvgpr_write_b32 a155, 0
  v_accvgpr_write_b32 a156, 0
  v_accvgpr_write_b32 a157, 0
  v_accvgpr_write_b32 a158, 0
  v_accvgpr_write_b32 a159, 0
  v_accvgpr_write_b32 a160, 0
  v_accvgpr_write_b32 a161, 0
  v_accvgpr_write_b32 a162, 0
  v_accvgpr_write_b32 a163, 0
  v_accvgpr_write_b32 a164, 0
  v_accvgpr_write_b32 a165, 0
  v_accvgpr_write_b32 a166, 0
  v_accvgpr_write_b32 a167, 0
  v_accvgpr_write_b32 a168, 0
  v_accvgpr_write_b32 a169, 0
  v_accvgpr_write_b32 a170, 0
  v_accvgpr_write_b32 a171, 0
  v_accvgpr_write_b32 a172, 0
  v_accvgpr_write_b32 a173, 0
  v_accvgpr_write_b32 a174, 0
  v_accvgpr_write_b32 a175, 0
  v_accvgpr_write_b32 a176, 0
  v_accvgpr_write_b32 a177, 0
  v_accvgpr_write_b32 a178, 0
  v_accvgpr_write_b32 a179, 0
  v_accvgpr_write_b32 a180, 0
  v_accvgpr_write_b32 a181, 0
  v_accvgpr_write_b32 a182, 0
  v_accvgpr_write_b32 a183, 0
  v_accvgpr_write_b32 a184, 0
  v_accvgpr_write_b32 a185, 0
  v_accvgpr_write_b32 a186, 0
  v_accvgpr_write_b32 a187, 0
  v_accvgpr_write_b32 a188, 0
  v_accvgpr_write_b32 a189, 0
  v_accvgpr_write_b32 a190, 0
  v_accvgpr_write_b32 a191, 0
  v_accvgpr_write_b32 a192, 0
  v_accvgpr_write_b32 a193, 0
  v_accvgpr_write_b32 a194, 0
  v_accvgpr_write_b32 a195, 0
  v_accvgpr_write_b32 a196, 0
  v_accvgpr_write_b32 a197, 0
  v_accvgpr_write_b32 a198, 0
  v_accvgpr_write_b32 a199, 0
  v_accvgpr_write_b32 a200, 0
  v_accvgpr_write_b32 a201, 0
  v_accvgpr_write_b32 a202, 0
  v_accvgpr_write_b32 a203, 0
  v_accvgpr_write_b32 a204, 0
  v_accvgpr_write_b32 a205, 0
  v_accvgpr_write_b32 a206, 0
  v_accvgpr_write_b32 a207, 0
  v_accvgpr_write_b32 a208, 0
  v_accvgpr_write_b32 a209, 0
  v_accvgpr_write_b32 a210, 0
  v_accvgpr_write_b32 a211, 0
  v_accvgpr_write_b32 a212, 0
  v_accvgpr_write_b32 a213, 0
  v_accvgpr_write_b32 a214, 0
  v_accvgpr_write_b32 a215, 0
  v_accvgpr_write_b32 a216, 0
  v_accvgpr_write_b32 a217, 0
  v_accvgpr_write_b32 a218, 0
  v_accvgpr_write_b32 a219, 0
  v_accvgpr_write_b32 a220, 0
  v_accvgpr_write_b32 a221, 0
  v_accvgpr_write_b32 a222, 0
  v_accvgpr_write_b32 a223, 0
  v_accvgpr_write_b32 a224, 0
  v_accvgpr_write_b32 a225, 0
  v_accvgpr_write_b32 a226, 0
  v_accvgpr_write_b32 a227, 0
  v_accvgpr_write_b32 a228, 0
  v_accvgpr_write_b32 a229, 0
  v_accvgpr_write_b32 a230, 0
  v_accvgpr_write_b32 a231, 0
  v_accvgpr_write_b32 a232, 0
  v_accvgpr_write_b32 a233, 0
  v_accvgpr_write_b32 a234, 0
  v_accvgpr_write_b32 a235, 0
  v_accvgpr_write_b32 a236, 0
  v_accvgpr_write_b32 a237, 0
  v_accvgpr_write_b32 a238, 0
  v_accvgpr_write_b32 a239, 0
  v_accvgpr_write_b32 a240, 0
  v_accvgpr_write_b32 a241, 0
  v_accvgpr_write_b32 a242, 0
  v_accvgpr_write_b32 a243, 0
  v_accvgpr_write_b32 a244, 0
  v_accvgpr_write_b32 a245, 0
  v_accvgpr_write_b32 a246, 0
  v_accvgpr_write_b32 a247, 0
  v_accvgpr_write_b32 a248, 0
  v_accvgpr_write_b32 a249, 0
  v_accvgpr_write_b32 a250, 0
  v_accvgpr_write_b32 a251, 0
  v_accvgpr_write_b32 a252, 0
  v_accvgpr_write_b32 a253, 0
  v_accvgpr_write_b32 a254, 0
  v_accvgpr_write_b32 a255, 0
  v_mov_b32 v12, 0
  v_mov_b32 v13, 0
  v_mov_b32 v14, 0
  v_mov_b32 v15, 0
  s_mov_b32 s26, 16
  s_barrier
L_p2:
  s_add_u32 m0, s25, 0
  s_nop 0
  buffer_load_dwordx4 v4, s[8:11], s32 offen offset:0 lds
  buffer_load_dwordx4 v4, s[8:11], s33 offen offset:1024 lds
  buffer_load_dwordx4 v4, s[8:11], s34 offen offset:2048 lds
  buffer_load_dwordx4 v4, s[8:11], s35 offen offset:3072 lds
  s_add_u32 m0, s25, 8192
  s_nop 0
  buffer_load_dwordx4 v5, s[12:15], s48 offen offset:0 lds
  buffer_load_dwordx4 v5, s[12:15], s49 offen offset:1024 lds
  buffer_load_dwordx4 v5, s[12:15], s50 offen offset:2048 lds
  buffer_load_dwordx4 v5, s[12:15], s51 offen offset:3072 lds
  s_add_u32 m0, s25, 16384
  s_nop 0
  buffer_load_dwordx4 v4, s[8:11], s36 offen offset:0 lds
  buffer_load_dwordx4 v4, s[8:11], s37 offen offset:1024 lds
  buffer_load_dwordx4 v4, s[8:11], s38 offen offset:2048 lds
  buffer_load_dwordx4 v4, s[8:11], s39 offen offset:3072 lds
  s_add_u32 m0, s25, 24576
  s_nop 0
  buffer_load_dwordx4 v5, s[12:15], s52 offen offset:0 lds
  buffer_load_dwordx4 v5, s[12:15], s53 offen offset:1024 lds
  buffer_load_dwordx4 v5, s[12:15], s54 offen offset:2048 lds
  buffer_load_dwordx4 v5, s[12:15], s55 offen offset:3072 lds
  s_add_u32 m0, s25, 32768
  s_nop 0
  buffer_load_dwordx4 v4, s[8:11], s40 offen offset:0 lds
  buffer_load_dwordx4 v4, s[8:11], s41 offen offset:1024 lds
  buffer_load_dwordx4 v4, s[8:11], s42 offen offset:2048 lds
  buffer_load_dwordx4 v4, s[8:11], s43 offen offset:3072 lds
  s_add_u32 m0, s25, 40960
  s_nop 0
  buffer_load_dwordx4 v5, s[12:15], s56 offen offset:0 lds
  buffer_load_dwordx4 v5, s[12:15], s57 offen offset:1024 lds
  buffer_load_dwordx4 v5, s[12:15], s58 offen offset:2048 lds
  buffer_load_dwordx4 v5, s[12:15], s59 offen offset:3072 lds
  s_add_u32 m0, s25, 49152
  s_nop 0
  buffer_load_dwordx4 v4, s[8:11], s44 offen offset:0 lds
  buffer_load_dwordx4 v4, s[8:11], s45 offen offset:1024 lds
  buffer_load_dwordx4 v4, s[8:11], s46 offen offset:2048 lds
  buffer_load_dwordx4 v4, s[8:11], s47 offen offset:3072 lds
  s_add_u32 m0, s25, 57344
  s_nop 0
  buffer_load_dwordx4 v5, s[12:15], s60 offen offset:0 lds
  buffer_load_dwordx4 v5, s[12:15], s61 offen offset:1024 lds
  buffer_load_dwordx4 v5, s[12:15], s62 offen offset:2048 lds
  buffer_load_dwordx4 v5, s[12:15], s63 offen offset:3072 lds
  v_add_u32 v4, 0x8000, v4
  s_waitcnt vmcnt(0)
  s_barrier
  ds_read_b128 v[16:19], v1 offset:0
  ds_read_b128 v[20:23], v1 offset:512
  ds_read_b128 v[24:27], v1 offset:2048
  ds_read_b128 v[28:31], v1 offset:2560
  ds_read_b128 v[32:35], v1 offset:4096
  ds_read_b128 v[36:39], v1 offset:4608
  ds_read_b128 v[40:43], v1 offset:6144
  ds_read_b128 v[44:47], v1 offset:6656
  s_waitcnt lgkmcnt(0)
  v_mfma_f32_16x16x32_bf16 v[112:115], v[16:19], a[0:3], 0
  v_mfma_f32_16x16x32_bf16 v[112:115], v[20:23], a[4:7], v[112:115]
  v_mfma_f32_16x16x32_bf16 v[112:115], v[24:27], a[8:11], v[112:115]
  v_mfma_f32_16x16x32_bf16 v[112:115], v[28:31], a[12:15], v[112:115]
  v_mfma_f32_16x16x32_bf16 v[112:115], v[32:35], a[16:19], v[112:115]
  v_mfma_f32_16x16x32_bf16 v[112:115], v[36:39], a[20:23], v[112:115]
  v_mfma_f32_16x16x32_bf16 v[112:115], v[40:43], a[24:27], v[112:115]
  v_mfma_f32_16x16x32_bf16 v[112:115], v[44:47], a[28:31], v[112:115]
  v_mfma_f32_16x16x32_bf16 v[116:119], v[16:19], a[32:35], 0
  v_mfma_f32_16x16x32_bf16 v[116:119], v[20:23], a[36:39], v[116:119]
  v_mfma_f32_16x16x32_bf16 v[116:119], v[24:27], a[40:43], v[116:119]
  v_mfma_f32_16x16x32_bf16 v[116:119], v[28:31], a[44:47], v[116:119]
  v_mfma_f32_16x16x32_bf16 v[116:119], v[32:35], a[48:51], v[116:119]
  v_mfma_f32_16x16x32_bf16 v[116:119], v[36:39], a[52:55], v[116:119]
  v_mfma_f32_16x16x32_bf16 v[116:119], v[40:43], a[56:59], v[116:119]
  v_mfma_f32_16x16x32_bf16 v[116:119], v[44:47], a[60:63], v[116:119]
  v_mfma_f32_16x16x32_bf16 v[120:123], v[16:19], a[64:67], 0
  v_mfma_f32_16x16x32_bf16 v[120:123], v[20:23], a[68:71], v[120:123]
  v_mfma_f32_16x16x32_bf16 v[120:123], v[24:27], a[72:75], v[120:123]
  v_mfma_f32_16x16x32_bf16 v[120:123], v[28:31], a[76:79], v[120:123]
  v_mfma_f32_16x16x32_bf16 v[120:123], v[32:35], a[80:83], v[120:123]
  v_mfma_f32_16x16x32_bf16 v[120:123], v[36:39], a[84:87], v[120:123]
  v_mfma_f32_16x16x32_bf16 v[120:123], v[40:43], a[88:91], v[120:123]
  v_mfma_f32_16x16x32_bf16 v[120:123], v[44:47], a[92:95], v[120:123]
  v_mfma_f32_16x16x32_bf16 v[124:127], v[16:19], a[96:99], 0
  v_mfma_f32_16x16x32_bf16 v[124:127], v[20:23], a[100:103], v[124:127]
  v_mfma_f32_16x16x32_bf16 v[124:127], v[24:27], a[104:107], v[124:127]
  v_mfma_f32_16x16x32_bf16 v[124:127], v[28:31], a[108:111], v[124:127]
  v_mfma_f32_16x16x32_bf16 v[124:127], v[32:35], a[112:115], v[124:127]
  v_mfma_f32_16x16x32_bf16 v[124:127], v[36:39], a[116:119], v[124:127]
  v_mfma_f32_16x16x32_bf16 v[124:127], v[40:43], a[120:123], v[124:127]
  v_mfma_f32_16x16x32_bf16 v[124:127], v[44:47], a[124:127], v[124:127]
  s_nop 7
  s_nop 3
  v_sub_f32 v112, v112, v48
  v_sub_f32 v113, v113, v48
  v_sub_f32 v114, v114, v48
  v_sub_f32 v115, v115, v48
  v_exp_f32 v8, v112
  v_exp_f32 v9, v113
  v_add_f32 v12, v12, v8
  v_cvt_pk_bf16_f32 v80, v8, v9
  v_add_f32 v12, v12, v9
  v_exp_f32 v10, v114
  v_exp_f32 v11, v115
  v_add_f32 v12, v12, v10
  v_cvt_pk_bf16_f32 v81, v10, v11
  v_add_f32 v12, v12, v11
  s_nop 0
  v_sub_f32 v116, v116, v49
  v_sub_f32 v117, v117, v49
  v_sub_f32 v118, v118, v49
  v_sub_f32 v119, v119, v49
  v_exp_f32 v8, v116
  v_exp_f32 v9, v117
  v_add_f32 v13, v13, v8
  v_cvt_pk_bf16_f32 v88, v8, v9
  v_add_f32 v13, v13, v9
  v_exp_f32 v10, v118
  v_exp_f32 v11, v119
  v_add_f32 v13, v13, v10
  v_cvt_pk_bf16_f32 v89, v10, v11
  v_add_f32 v13, v13, v11
  s_nop 0
  v_sub_f32 v120, v120, v50
  v_sub_f32 v121, v121, v50
  v_sub_f32 v122, v122, v50
  v_sub_f32 v123, v123, v50
  v_exp_f32 v8, v120
  v_exp_f32 v9, v121
  v_add_f32 v14, v14, v8
  v_cvt_pk_bf16_f32 v96, v8, v9
  v_add_f32 v14, v14, v9
  v_exp_f32 v10, v122
  v_exp_f32 v11, v123
  v_add_f32 v14, v14, v10
  v_cvt_pk_bf16_f32 v97, v10, v11
  v_add_f32 v14, v14, v11
  s_nop 0
  v_sub_f32 v124, v124, v51
  v_sub_f32 v125, v125, v51
  v_sub_f32 v126, v126, v51
  v_sub_f32 v127, v127, v51
  v_exp_f32 v8, v124
  v_exp_f32 v9, v125
  v_add_f32 v15, v15, v8
  v_cvt_pk_bf16_f32 v104, v8, v9
  v_add_f32 v15, v15, v9
  v_exp_f32 v10, v126
  v_exp_f32 v11, v127
  v_add_f32 v15, v15, v10
  v_cvt_pk_bf16_f32 v105, v10, v11
  v_add_f32 v15, v15, v11
  s_nop 0
  ds_read_b128 v[16:19], v1 offset:16384
  ds_read_b128 v[20:23], v1 offset:16896
  ds_read_b128 v[24:27], v1 offset:18432
  ds_read_b128 v[28:31], v1 offset:18944
  ds_read_b128 v[32:35], v1 offset:20480
  ds_read_b128 v[36:39], v1 offset:20992
  ds_read_b128 v[40:43], v1 offset:22528
  ds_read_b128 v[44:47], v1 offset:23040
  s_waitcnt lgkmcnt(0)
  v_mfma_f32_16x16x32_bf16 v[112:115], v[16:19], a[0:3], 0
  v_mfma_f32_16x16x32_bf16 v[112:115], v[20:23], a[4:7], v[112:115]
  v_mfma_f32_16x16x32_bf16 v[112:115], v[24:27], a[8:11], v[112:115]
  v_mfma_f32_16x16x32_bf16 v[112:115], v[28:31], a[12:15], v[112:115]
  v_mfma_f32_16x16x32_bf16 v[112:115], v[32:35], a[16:19], v[112:115]
  v_mfma_f32_16x16x32_bf16 v[112:115], v[36:39], a[20:23], v[112:115]
  v_mfma_f32_16x16x32_bf16 v[112:115], v[40:43], a[24:27], v[112:115]
  v_mfma_f32_16x16x32_bf16 v[112:115], v[44:47], a[28:31], v[112:115]
  v_mfma_f32_16x16x32_bf16 v[116:119], v[16:19], a[32:35], 0
  v_mfma_f32_16x16x32_bf16 v[116:119], v[20:23], a[36:39], v[116:119]
  v_mfma_f32_16x16x32_bf16 v[116:119], v[24:27], a[40:43], v[116:119]
  v_mfma_f32_16x16x32_bf16 v[116:119], v[28:31], a[44:47], v[116:119]
  v_mfma_f32_16x16x32_bf16 v[116:119], v[32:35], a[48:51], v[116:119]
  v_mfma_f32_16x16x32_bf16 v[116:119], v[36:39], a[52:55], v[116:119]
  v_mfma_f32_16x16x32_bf16 v[116:119], v[40:43], a[56:59], v[116:119]
  v_mfma_f32_16x16x32_bf16 v[116:119], v[44:47], a[60:63], v[116:119]
  v_mfma_f32_16x16x32_bf16 v[120:123], v[16:19], a[64:67], 0
  v_mfma_f32_16x16x32_bf16 v[120:123], v[20:23], a[68:71], v[120:123]
  v_mfma_f32_16x16x32_bf16 v[120:123], v[24:27], a[72:75], v[120:123]
  v_mfma_f32_16x16x32_bf16 v[120:123], v[28:31], a[76:79], v[120:123]
  v_mfma_f32_16x16x32_bf16 v[120:123], v[32:35], a[80:83], v[120:123]
  v_mfma_f32_16x16x32_bf16 v[120:123], v[36:39], a[84:87], v[120:123]
  v_mfma_f32_16x16x32_bf16 v[120:123], v[40:43], a[88:91], v[120:123]
  v_mfma_f32_16x16x32_bf16 v[120:123], v[44:47], a[92:95], v[120:123]
  v_mfma_f32_16x16x32_bf16 v[124:127], v[16:19], a[96:99], 0
  v_mfma_f32_16x16x32_bf16 v[124:127], v[20:23], a[100:103], v[124:127]
  v_mfma_f32_16x16x32_bf16 v[124:127], v[24:27], a[104:107], v[124:127]
  v_mfma_f32_16x16x32_bf16 v[124:127], v[28:31], a[108:111], v[124:127]
  v_mfma_f32_16x16x32_bf16 v[124:127], v[32:35], a[112:115], v[124:127]
  v_mfma_f32_16x16x32_bf16 v[124:127], v[36:39], a[116:119], v[124:127]
  v_mfma_f32_16x16x32_bf16 v[124:127], v[40:43], a[120:123], v[124:127]
  v_mfma_f32_16x16x32_bf16 v[124:127], v[44:47], a[124:127], v[124:127]
  s_nop 7
  s_nop 3
  v_sub_f32 v112, v112, v48
  v_sub_f32 v113, v113, v48
  v_sub_f32 v114, v114, v48
  v_sub_f32 v115, v115, v48
  v_exp_f32 v8, v112
  v_exp_f32 v9, v113
  v_add_f32 v12, v12, v8
  v_cvt_pk_bf16_f32 v82, v8, v9
  v_add_f32 v12, v12, v9
  v_exp_f32 v10, v114
  v_exp_f32 v11, v115
  v_add_f32 v12, v12, v10
  v_cvt_pk_bf16_f32 v83, v10, v11
  v_add_f32 v12, v12, v11
  s_nop 0
  v_sub_f32 v116, v116, v49
  v_sub_f32 v117, v117, v49
  v_sub_f32 v118, v118, v49
  v_sub_f32 v119, v119, v49
  v_exp_f32 v8, v116
  v_exp_f32 v9, v117
  v_add_f32 v13, v13, v8
  v_cvt_pk_bf16_f32 v90, v8, v9
  v_add_f32 v13, v13, v9
  v_exp_f32 v10, v118
  v_exp_f32 v11, v119
  v_add_f32 v13, v13, v10
  v_cvt_pk_bf16_f32 v91, v10, v11
  v_add_f32 v13, v13, v11
  s_nop 0
  v_sub_f32 v120, v120, v50
  v_sub_f32 v121, v121, v50
  v_sub_f32 v122, v122, v50
  v_sub_f32 v123, v123, v50
  v_exp_f32 v8, v120
  v_exp_f32 v9, v121
  v_add_f32 v14, v14, v8
  v_cvt_pk_bf16_f32 v98, v8, v9
  v_add_f32 v14, v14, v9
  v_exp_f32 v10, v122
  v_exp_f32 v11, v123
  v_add_f32 v14, v14, v10
  v_cvt_pk_bf16_f32 v99, v10, v11
  v_add_f32 v14, v14, v11
  s_nop 0
  v_sub_f32 v124, v124, v51
  v_sub_f32 v125, v125, v51
  v_sub_f32 v126, v126, v51
  v_sub_f32 v127, v127, v51
  v_exp_f32 v8, v124
  v_exp_f32 v9, v125
  v_add_f32 v15, v15, v8
  v_cvt_pk_bf16_f32 v106, v8, v9
  v_add_f32 v15, v15, v9
  v_exp_f32 v10, v126
  v_exp_f32 v11, v127
  v_add_f32 v15, v15, v10
  v_cvt_pk_bf16_f32 v107, v10, v11
  v_add_f32 v15, v15, v11
  s_nop 0
  ds_read_b128 v[16:19], v1 offset:32768
  ds_read_b128 v[20:23], v1 offset:33280
  ds_read_b128 v[24:27], v1 offset:34816
  ds_read_b128 v[28:31], v1 offset:35328
  ds_read_b128 v[32:35], v1 offset:36864
  ds_read_b128 v[36:39], v1 offset:37376
  ds_read_b128 v[40:43], v1 offset:38912
  ds_read_b128 v[44:47], v1 offset:39424
  s_waitcnt lgkmcnt(0)
  v_mfma_f32_16x16x32_bf16 v[112:115], v[16:19], a[0:3], 0
  v_mfma_f32_16x16x32_bf16 v[112:115], v[20:23], a[4:7], v[112:115]
  v_mfma_f32_16x16x32_bf16 v[112:115], v[24:27], a[8:11], v[112:115]
  v_mfma_f32_16x16x32_bf16 v[112:115], v[28:31], a[12:15], v[112:115]
  v_mfma_f32_16x16x32_bf16 v[112:115], v[32:35], a[16:19], v[112:115]
  v_mfma_f32_16x16x32_bf16 v[112:115], v[36:39], a[20:23], v[112:115]
  v_mfma_f32_16x16x32_bf16 v[112:115], v[40:43], a[24:27], v[112:115]
  v_mfma_f32_16x16x32_bf16 v[112:115], v[44:47], a[28:31], v[112:115]
  v_mfma_f32_16x16x32_bf16 v[116:119], v[16:19], a[32:35], 0
  v_mfma_f32_16x16x32_bf16 v[116:119], v[20:23], a[36:39], v[116:119]
  v_mfma_f32_16x16x32_bf16 v[116:119], v[24:27], a[40:43], v[116:119]
  v_mfma_f32_16x16x32_bf16 v[116:119], v[28:31], a[44:47], v[116:119]
  v_mfma_f32_16x16x32_bf16 v[116:119], v[32:35], a[48:51], v[116:119]
  v_mfma_f32_16x16x32_bf16 v[116:119], v[36:39], a[52:55], v[116:119]
  v_mfma_f32_16x16x32_bf16 v[116:119], v[40:43], a[56:59], v[116:119]
  v_mfma_f32_16x16x32_bf16 v[116:119], v[44:47], a[60:63], v[116:119]
  v_mfma_f32_16x16x32_bf16 v[120:123], v[16:19], a[64:67], 0
  v_mfma_f32_16x16x32_bf16 v[120:123], v[20:23], a[68:71], v[120:123]
  v_mfma_f32_16x16x32_bf16 v[120:123], v[24:27], a[72:75], v[120:123]
  v_mfma_f32_16x16x32_bf16 v[120:123], v[28:31], a[76:79], v[120:123]
  v_mfma_f32_16x16x32_bf16 v[120:123], v[32:35], a[80:83], v[120:123]
  v_mfma_f32_16x16x32_bf16 v[120:123], v[36:39], a[84:87], v[120:123]
  v_mfma_f32_16x16x32_bf16 v[120:123], v[40:43], a[88:91], v[120:123]
  v_mfma_f32_16x16x32_bf16 v[120:123], v[44:47], a[92:95], v[120:123]
  v_mfma_f32_16x16x32_bf16 v[124:127], v[16:19], a[96:99], 0
  v_mfma_f32_16x16x32_bf16 v[124:127], v[20:23], a[100:103], v[124:127]
  v_mfma_f32_16x16x32_bf16 v[124:127], v[24:27], a[104:107], v[124:127]
  v_mfma_f32_16x16x32_bf16 v[124:127], v[28:31], a[108:111], v[124:127]
  v_mfma_f32_16x16x32_bf16 v[124:127], v[32:35], a[112:115], v[124:127]
  v_mfma_f32_16x16x32_bf16 v[124:127], v[36:39], a[116:119], v[124:127]
  v_mfma_f32_16x16x32_bf16 v[124:127], v[40:43], a[120:123], v[124:127]
  v_mfma_f32_16x16x32_bf16 v[124:127], v[44:47], a[124:127], v[124:127]
  s_nop 7
  s_nop 3
  v_sub_f32 v112, v112, v48
  v_sub_f32 v113, v113, v48
  v_sub_f32 v114, v114, v48
  v_sub_f32 v115, v115, v48
  v_exp_f32 v8, v112
  v_exp_f32 v9, v113
  v_add_f32 v12, v12, v8
  v_cvt_pk_bf16_f32 v84, v8, v9
  v_add_f32 v12, v12, v9
  v_exp_f32 v10, v114
  v_exp_f32 v11, v115
  v_add_f32 v12, v12, v10
  v_cvt_pk_bf16_f32 v85, v10, v11
  v_add_f32 v12, v12, v11
  s_nop 0
  v_sub_f32 v116, v116, v49
  v_sub_f32 v117, v117, v49
  v_sub_f32 v118, v118, v49
  v_sub_f32 v119, v119, v49
  v_exp_f32 v8, v116
  v_exp_f32 v9, v117
  v_add_f32 v13, v13, v8
  v_cvt_pk_bf16_f32 v92, v8, v9
  v_add_f32 v13, v13, v9
  v_exp_f32 v10, v118
  v_exp_f32 v11, v119
  v_add_f32 v13, v13, v10
  v_cvt_pk_bf16_f32 v93, v10, v11
  v_add_f32 v13, v13, v11
  s_nop 0
  v_sub_f32 v120, v120, v50
  v_sub_f32 v121, v121, v50
  v_sub_f32 v122, v122, v50
  v_sub_f32 v123, v123, v50
  v_exp_f32 v8, v120
  v_exp_f32 v9, v121
  v_add_f32 v14, v14, v8
  v_cvt_pk_bf16_f32 v100, v8, v9
  v_add_f32 v14, v14, v9
  v_exp_f32 v10, v122
  v_exp_f32 v11, v123
  v_add_f32 v14, v14, v10
  v_cvt_pk_bf16_f32 v101, v10, v11
  v_add_f32 v14, v14, v11
  s_nop 0
  v_sub_f32 v124, v124, v51
  v_sub_f32 v125, v125, v51
  v_sub_f32 v126, v126, v51
  v_sub_f32 v127, v127, v51
  v_exp_f32 v8, v124
  v_exp_f32 v9, v125
  v_add_f32 v15, v15, v8
  v_cvt_pk_bf16_f32 v108, v8, v9
  v_add_f32 v15, v15, v9
  v_exp_f32 v10, v126
  v_exp_f32 v11, v127
  v_add_f32 v15, v15, v10
  v_cvt_pk_bf16_f32 v109, v10, v11
  v_add_f32 v15, v15, v11
  s_nop 0
  ds_read_b128 v[16:19], v1 offset:49152
  ds_read_b128 v[20:23], v1 offset:49664
  ds_read_b128 v[24:27], v1 offset:51200
  ds_read_b128 v[28:31], v1 offset:51712
  ds_read_b128 v[32:35], v1 offset:53248
  ds_read_b128 v[36:39], v1 offset:53760
  ds_read_b128 v[40:43], v1 offset:55296
  ds_read_b128 v[44:47], v1 offset:55808
  s_waitcnt lgkmcnt(0)
  v_mfma_f32_16x16x32_bf16 v[112:115], v[16:19], a[0:3], 0
  v_mfma_f32_16x16x32_bf16 v[112:115], v[20:23], a[4:7], v[112:115]
  v_mfma_f32_16x16x32_bf16 v[112:115], v[24:27], a[8:11], v[112:115]
  v_mfma_f32_16x16x32_bf16 v[112:115], v[28:31], a[12:15], v[112:115]
  v_mfma_f32_16x16x32_bf16 v[112:115], v[32:35], a[16:19], v[112:115]
  v_mfma_f32_16x16x32_bf16 v[112:115], v[36:39], a[20:23], v[112:115]
  v_mfma_f32_16x16x32_bf16 v[112:115], v[40:43], a[24:27], v[112:115]
  v_mfma_f32_16x16x32_bf16 v[112:115], v[44:47], a[28:31], v[112:115]
  v_mfma_f32_16x16x32_bf16 v[116:119], v[16:19], a[32:35], 0
  v_mfma_f32_16x16x32_bf16 v[116:119], v[20:23], a[36:39], v[116:119]
  v_mfma_f32_16x16x32_bf16 v[116:119], v[24:27], a[40:43], v[116:119]
  v_mfma_f32_16x16x32_bf16 v[116:119], v[28:31], a[44:47], v[116:119]
  v_mfma_f32_16x16x32_bf16 v[116:119], v[32:35], a[48:51], v[116:119]
  v_mfma_f32_16x16x32_bf16 v[116:119], v[36:39], a[52:55], v[116:119]
  v_mfma_f32_16x16x32_bf16 v[116:119], v[40:43], a[56:59], v[116:119]
  v_mfma_f32_16x16x32_bf16 v[116:119], v[44:47], a[60:63], v[116:119]
  v_mfma_f32_16x16x32_bf16 v[120:123], v[16:19], a[64:67], 0
  v_mfma_f32_16x16x32_bf16 v[120:123], v[20:23], a[68:71], v[120:123]
  v_mfma_f32_16x16x32_bf16 v[120:123], v[24:27], a[72:75], v[120:123]
  v_mfma_f32_16x16x32_bf16 v[120:123], v[28:31], a[76:79], v[120:123]
  v_mfma_f32_16x16x32_bf16 v[120:123], v[32:35], a[80:83], v[120:123]
  v_mfma_f32_16x16x32_bf16 v[120:123], v[36:39], a[84:87], v[120:123]
  v_mfma_f32_16x16x32_bf16 v[120:123], v[40:43], a[88:91], v[120:123]
  v_mfma_f32_16x16x32_bf16 v[120:123], v[44:47], a[92:95], v[120:123]
  v_mfma_f32_16x16x32_bf16 v[124:127], v[16:19], a[96:99], 0
  v_mfma_f32_16x16x32_bf16 v[124:127], v[20:23], a[100:103], v[124:127]
  v_mfma_f32_16x16x32_bf16 v[124:127], v[24:27], a[104:107], v[124:127]
  v_mfma_f32_16x16x32_bf16 v[124:127], v[28:31], a[108:111], v[124:127]
  v_mfma_f32_16x16x32_bf16 v[124:127], v[32:35], a[112:115], v[124:127]
  v_mfma_f32_16x16x32_bf16 v[124:127], v[36:39], a[116:119], v[124:127]
  v_mfma_f32_16x16x32_bf16 v[124:127], v[40:43], a[120:123], v[124:127]
  v_mfma_f32_16x16x32_bf16 v[124:127], v[44:47], a[124:127], v[124:127]
  s_nop 7
  s_nop 3
  v_sub_f32 v112, v112, v48
  v_sub_f32 v113, v113, v48
  v_sub_f32 v114, v114, v48
  v_sub_f32 v115, v115, v48
  v_exp_f32 v8, v112
  v_exp_f32 v9, v113
  v_add_f32 v12, v12, v8
  v_cvt_pk_bf16_f32 v86, v8, v9
  v_add_f32 v12, v12, v9
  v_exp_f32 v10, v114
  v_exp_f32 v11, v115
  v_add_f32 v12, v12, v10
  v_cvt_pk_bf16_f32 v87, v10, v11
  v_add_f32 v12, v12, v11
  s_nop 0
  v_sub_f32 v116, v116, v49
  v_sub_f32 v117, v117, v49
  v_sub_f32 v118, v118, v49
  v_sub_f32 v119, v119, v49
  v_exp_f32 v8, v116
  v_exp_f32 v9, v117
  v_add_f32 v13, v13, v8
  v_cvt_pk_bf16_f32 v94, v8, v9
  v_add_f32 v13, v13, v9
  v_exp_f32 v10, v118
  v_exp_f32 v11, v119
  v_add_f32 v13, v13, v10
  v_cvt_pk_bf16_f32 v95, v10, v11
  v_add_f32 v13, v13, v11
  s_nop 0
  v_sub_f32 v120, v120, v50
  v_sub_f32 v121, v121, v50
  v_sub_f32 v122, v122, v50
  v_sub_f32 v123, v123, v50
  v_exp_f32 v8, v120
  v_exp_f32 v9, v121
  v_add_f32 v14, v14, v8
  v_cvt_pk_bf16_f32 v102, v8, v9
  v_add_f32 v14, v14, v9
  v_exp_f32 v10, v122
  v_exp_f32 v11, v123
  v_add_f32 v14, v14, v10
  v_cvt_pk_bf16_f32 v103, v10, v11
  v_add_f32 v14, v14, v11
  s_nop 0
  v_sub_f32 v124, v124, v51
  v_sub_f32 v125, v125, v51
  v_sub_f32 v126, v126, v51
  v_sub_f32 v127, v127, v51
  v_exp_f32 v8, v124
  v_exp_f32 v9, v125
  v_add_f32 v15, v15, v8
  v_cvt_pk_bf16_f32 v110, v8, v9
  v_add_f32 v15, v15, v9
  v_exp_f32 v10, v126
  v_exp_f32 v11, v127
  v_add_f32 v15, v15, v10
  v_cvt_pk_bf16_f32 v111, v10, v11
  v_add_f32 v15, v15, v11
  s_nop 0
  s_cmp_eq_u32 s26, 1
  s_cbranch_scc1 L_fin
  v_add_u32 v5, 0x8000, v5
  ds_read_b64_tr_b16 v[16:17], v2 offset:8192
  ds_read_b64_tr_b16 v[18:19], v2 offset:10240
  ds_read_b64_tr_b16 v[20:21], v2 offset:12288
  ds_read_b64_tr_b16 v[22:23], v2 offset:14336
  ds_read_b64_tr_b16 v[24:25], v3 offset:8192
  ds_read_b64_tr_b16 v[26:27], v3 offset:10240
  ds_read_b64_tr_b16 v[28:29], v3 offset:12288
  ds_read_b64_tr_b16 v[30:31], v3 offset:14336
  s_waitcnt lgkmcnt(0)
  ds_read_b64_tr_b16 v[32:33], v2 offset:8704
  ds_read_b64_tr_b16 v[34:35], v2 offset:10752
  ds_read_b64_tr_b16 v[36:37], v2 offset:12800
  ds_read_b64_tr_b16 v[38:39], v2 offset:14848
  ds_read_b64_tr_b16 v[40:41], v3 offset:8704
  ds_read_b64_tr_b16 v[42:43], v3 offset:10752
  ds_read_b64_tr_b16 v[44:45], v3 offset:12800
  ds_read_b64_tr_b16 v[46:47], v3 offset:14848
  s_waitcnt lgkmcnt(0)
  v_mfma_f32_16x16x32_bf16 a[128:131], v[16:19], v[80:83], a[128:131]
  v_mfma_f32_16x16x32_bf16 a[128:131], v[20:23], v[84:87], a[128:131]
  v_mfma_f32_16x16x32_bf16 a[132:135], v[16:19], v[88:91], a[132:135]
  v_mfma_f32_16x16x32_bf16 a[132:135], v[20:23], v[92:95], a[132:135]
  v_mfma_f32_16x16x32_bf16 a[136:139], v[16:19], v[96:99], a[136:139]
  v_mfma_f32_16x16x32_bf16 a[136:139], v[20:23], v[100:103], a[136:139]
  v_mfma_f32_16x16x32_bf16 a[140:143], v[16:19], v[104:107], a[140:143]
  v_mfma_f32_16x16x32_bf16 a[140:143], v[20:23], v[108:111], a[140:143]
  v_mfma_f32_16x16x32_bf16 a[144:147], v[24:27], v[80:83], a[144:147]
  v_mfma_f32_16x16x32_bf16 a[144:147], v[28:31], v[84:87], a[144:147]
  v_mfma_f32_16x16x32_bf16 a[148:151], v[24:27], v[88:91], a[148:151]
  v_mfma_f32_16x16x32_bf16 a[148:151], v[28:31], v[92:95], a[148:151]
  v_mfma_f32_16x16x32_bf16 a[152:155], v[24:27], v[96:99], a[152:155]
  v_mfma_f32_16x16x32_bf16 a[152:155], v[28:31], v[100:103], a[152:155]
  v_mfma_f32_16x16x32_bf16 a[156:159], v[24:27], v[104:107], a[156:159]
  v_mfma_f32_16x16x32_bf16 a[156:159], v[28:31], v[108:111], a[156:159]
  v_mfma_f32_16x16x32_bf16 a[160:163], v[32:35], v[80:83], a[160:163]
  v_mfma_f32_16x16x32_bf16 a[160:163], v[36:39], v[84:87], a[160:163]
  v_mfma_f32_16x16x32_bf16 a[164:167], v[32:35], v[88:91], a[164:167]
  v_mfma_f32_16x16x32_bf16 a[164:167], v[36:39], v[92:95], a[164:167]
  v_mfma_f32_16x16x32_bf16 a[168:171], v[32:35], v[96:99], a[168:171]
  v_mfma_f32_16x16x32_bf16 a[168:171], v[36:39], v[100:103], a[168:171]
  v_mfma_f32_16x16x32_bf16 a[172:175], v[32:35], v[104:107], a[172:175]
  v_mfma_f32_16x16x32_bf16 a[172:175], v[36:39], v[108:111], a[172:175]
  v_mfma_f32_16x16x32_bf16 a[176:179], v[40:43], v[80:83], a[176:179]
  v_mfma_f32_16x16x32_bf16 a[176:179], v[44:47], v[84:87], a[176:179]
  v_mfma_f32_16x16x32_bf16 a[180:183], v[40:43], v[88:91], a[180:183]
  v_mfma_f32_16x16x32_bf16 a[180:183], v[44:47], v[92:95], a[180:183]
  v_mfma_f32_16x16x32_bf16 a[184:187], v[40:43], v[96:99], a[184:187]
  v_mfma_f32_16x16x32_bf16 a[184:187], v[44:47], v[100:103], a[184:187]
  v_mfma_f32_16x16x32_bf16 a[188:191], v[40:43], v[104:107], a[188:191]
  v_mfma_f32_16x16x32_bf16 a[188:191], v[44:47], v[108:111], a[188:191]
  s_nop 7
  s_nop 3
  ds_read_b64_tr_b16 v[16:17], v2 offset:24576
  ds_read_b64_tr_b16 v[18:19], v2 offset:26624
  ds_read_b64_tr_b16 v[20:21], v2 offset:28672
  ds_read_b64_tr_b16 v[22:23], v2 offset:30720
  ds_read_b64_tr_b16 v[24:25], v3 offset:24576
  ds_read_b64_tr_b16 v[26:27], v3 offset:26624
  ds_read_b64_tr_b16 v[28:29], v3 offset:28672
  ds_read_b64_tr_b16 v[30:31], v3 offset:30720
  s_waitcnt lgkmcnt(0)
  ds_read_b64_tr_b16 v[32:33], v2 offset:25088
  ds_read_b64_tr_b16 v[34:35], v2 offset:27136
  ds_read_b64_tr_b16 v[36:37], v2 offset:29184
  ds_read_b64_tr_b16 v[38:39], v2 offset:31232
  ds_read_b64_tr_b16 v[40:41], v3 offset:25088
  ds_read_b64_tr_b16 v[42:43], v3 offset:27136
  ds_read_b64_tr_b16 v[44:45], v3 offset:29184
  ds_read_b64_tr_b16 v[46:47], v3 offset:31232
  s_waitcnt lgkmcnt(0)
  v_mfma_f32_16x16x32_bf16 a[192:195], v[16:19], v[80:83], a[192:195]
  v_mfma_f32_16x16x32_bf16 a[192:195], v[20:23], v[84:87], a[192:195]
  v_mfma_f32_16x16x32_bf16 a[196:199], v[16:19], v[88:91], a[196:199]
  v_mfma_f32_16x16x32_bf16 a[196:199], v[20:23], v[92:95], a[196:199]
  v_mfma_f32_16x16x32_bf16 a[200:203], v[16:19], v[96:99], a[200:203]
  v_mfma_f32_16x16x32_bf16 a[200:203], v[20:23], v[100:103], a[200:203]
  v_mfma_f32_16x16x32_bf16 a[204:207], v[16:19], v[104:107], a[204:207]
  v_mfma_f32_16x16x32_bf16 a[204:207], v[20:23], v[108:111], a[204:207]
  v_mfma_f32_16x16x32_bf16 a[208:211], v[24:27], v[80:83], a[208:211]
  v_mfma_f32_16x16x32_bf16 a[208:211], v[28:31], v[84:87], a[208:211]
  v_mfma_f32_16x16x32_bf16 a[212:215], v[24:27], v[88:91], a[212:215]
  v_mfma_f32_16x16x32_bf16 a[212:215], v[28:31], v[92:95], a[212:215]
  v_mfma_f32_16x16x32_bf16 a[216:219], v[24:27], v[96:99], a[216:219]
  v_mfma_f32_16x16x32_bf16 a[216:219], v[28:31], v[100:103], a[216:219]
  v_mfma_f32_16x16x32_bf16 a[220:223], v[24:27], v[104:107], a[220:223]
  v_mfma_f32_16x16x32_bf16 a[220:223], v[28:31], v[108:111], a[220:223]
  v_mfma_f32_16x16x32_bf16 a[224:227], v[32:35], v[80:83], a[224:227]
  v_mfma_f32_16x16x32_bf16 a[224:227], v[36:39], v[84:87], a[224:227]
  v_mfma_f32_16x16x32_bf16 a[228:231], v[32:35], v[88:91], a[228:231]
  v_mfma_f32_16x16x32_bf16 a[228:231], v[36:39], v[92:95], a[228:231]
  v_mfma_f32_16x16x32_bf16 a[232:235], v[32:35], v[96:99], a[232:235]
  v_mfma_f32_16x16x32_bf16 a[232:235], v[36:39], v[100:103], a[232:235]
  v_mfma_f32_16x16x32_bf16 a[236:239], v[32:35], v[104:107], a[236:239]
  v_mfma_f32_16x16x32_bf16 a[236:239], v[36:39], v[108:111], a[236:239]
  v_mfma_f32_16x16x32_bf16 a[240:243], v[40:43], v[80:83], a[240:243]
  v_mfma_f32_16x16x32_bf16 a[240:243], v[44:47], v[84:87], a[240:243]
  v_mfma_f32_16x16x32_bf16 a[244:247], v[40:43], v[88:91], a[244:247]
  v_mfma_f32_16x16x32_bf16 a[244:247], v[44:47], v[92:95], a[244:247]
  v_mfma_f32_16x16x32_bf16 a[248:251], v[40:43], v[96:99], a[248:251]
  v_mfma_f32_16x16x32_bf16 a[248:251], v[44:47], v[100:103], a[248:251]
  v_mfma_f32_16x16x32_bf16 a[252:255], v[40:43], v[104:107], a[252:255]
  v_mfma_f32_16x16x32_bf16 a[252:255], v[44:47], v[108:111], a[252:255]
  s_nop 7
  s_nop 3
  ds_read_b64_tr_b16 v[16:17], v2 offset:40960
  ds_read_b64_tr_b16 v[18:19], v2 offset:43008
  ds_read_b64_tr_b16 v[20:21], v2 offset:45056
  ds_read_b64_tr_b16 v[22:23], v2 offset:47104
  ds_read_b64_tr_b16 v[24:25], v3 offset:40960
  ds_read_b64_tr_b16 v[26:27], v3 offset:43008
  ds_read_b64_tr_b16 v[28:29], v3 offset:45056
  ds_read_b64_tr_b16 v[30:31], v3 offset:47104
  s_waitcnt lgkmcnt(0)
  ds_read_b64_tr_b16 v[32:33], v2 offset:41472
  ds_read_b64_tr_b16 v[34:35], v2 offset:43520
  ds_read_b64_tr_b16 v[36:37], v2 offset:45568
  ds_read_b64_tr_b16 v[38:39], v2 offset:47616
  ds_read_b64_tr_b16 v[40:41], v3 offset:41472
  ds_read_b64_tr_b16 v[42:43], v3 offset:43520
  ds_read_b64_tr_b16 v[44:45], v3 offset:45568
  ds_read_b64_tr_b16 v[46:47], v3 offset:47616
  s_waitcnt lgkmcnt(0)
  v_mfma_f32_16x16x32_bf16 v[128:131], v[16:19], v[80:83], v[128:131]
  v_mfma_f32_16x16x32_bf16 v[128:131], v[20:23], v[84:87], v[128:131]
  v_mfma_f32_16x16x32_bf16 v[132:135], v[16:19], v[88:91], v[132:135]
  v_mfma_f32_16x16x32_bf16 v[132:135], v[20:23], v[92:95], v[132:135]
  v_mfma_f32_16x16x32_bf16 v[136:139], v[16:19], v[96:99], v[136:139]
  v_mfma_f32_16x16x32_bf16 v[136:139], v[20:23], v[100:103], v[136:139]
  v_mfma_f32_16x16x32_bf16 v[140:143], v[16:19], v[104:107], v[140:143]
  v_mfma_f32_16x16x32_bf16 v[140:143], v[20:23], v[108:111], v[140:143]
  v_mfma_f32_16x16x32_bf16 v[144:147], v[24:27], v[80:83], v[144:147]
  v_mfma_f32_16x16x32_bf16 v[144:147], v[28:31], v[84:87], v[144:147]
  v_mfma_f32_16x16x32_bf16 v[148:151], v[24:27], v[88:91], v[148:151]
  v_mfma_f32_16x16x32_bf16 v[148:151], v[28:31], v[92:95], v[148:151]
  v_mfma_f32_16x16x32_bf16 v[152:155], v[24:27], v[96:99], v[152:155]
  v_mfma_f32_16x16x32_bf16 v[152:155], v[28:31], v[100:103], v[152:155]
  v_mfma_f32_16x16x32_bf16 v[156:159], v[24:27], v[104:107], v[156:159]
  v_mfma_f32_16x16x32_bf16 v[156:159], v[28:31], v[108:111], v[156:159]
  v_mfma_f32_16x16x32_bf16 v[160:163], v[32:35], v[80:83], v[160:163]
  v_mfma_f32_16x16x32_bf16 v[160:163], v[36:39], v[84:87], v[160:163]
  v_mfma_f32_16x16x32_bf16 v[164:167], v[32:35], v[88:91], v[164:167]
  v_mfma_f32_16x16x32_bf16 v[164:167], v[36:39], v[92:95], v[164:167]
  v_mfma_f32_16x16x32_bf16 v[168:171], v[32:35], v[96:99], v[168:171]
  v_mfma_f32_16x16x32_bf16 v[168:171], v[36:39], v[100:103], v[168:171]
  v_mfma_f32_16x16x32_bf16 v[172:175], v[32:35], v[104:107], v[172:175]
  v_mfma_f32_16x16x32_bf16 v[172:175], v[36:39], v[108:111], v[172:175]
  v_mfma_f32_16x16x32_bf16 v[176:179], v[40:43], v[80:83], v[176:179]
  v_mfma_f32_16x16x32_bf16 v[176:179], v[44:47], v[84:87], v[176:179]
  v_mfma_f32_16x16x32_bf16 v[180:183], v[40:43], v[88:91], v[180:183]
  v_mfma_f32_16x16x32_bf16 v[180:183], v[44:47], v[92:95], v[180:183]
  v_mfma_f32_16x16x32_bf16 v[184:187], v[40:43], v[96:99], v[184:187]
  v_mfma_f32_16x16x32_bf16 v[184:187], v[44:47], v[100:103], v[184:187]
  v_mfma_f32_16x16x32_bf16 v[188:191], v[40:43], v[104:107], v[188:191]
  v_mfma_f32_16x16x32_bf16 v[188:191], v[44:47], v[108:111], v[188:191]
  s_nop 7
  s_nop 3
  ds_read_b64_tr_b16 v[16:17], v2 offset:57344
  ds_read_b64_tr_b16 v[18:19], v2 offset:59392
  ds_read_b64_tr_b16 v[20:21], v2 offset:61440
  ds_read_b64_tr_b16 v[22:23], v2 offset:63488
  ds_read_b64_tr_b16 v[24:25], v3 offset:57344
  ds_read_b64_tr_b16 v[26:27], v3 offset:59392
  ds_read_b64_tr_b16 v[28:29], v3 offset:61440
  ds_read_b64_tr_b16 v[30:31], v3 offset:63488
  s_waitcnt lgkmcnt(0)
  ds_read_b64_tr_b16 v[32:33], v2 offset:57856
  ds_read_b64_tr_b16 v[34:35], v2 offset:59904
  ds_read_b64_tr_b16 v[36:37], v2 offset:61952
  ds_read_b64_tr_b16 v[38:39], v2 offset:64000
  ds_read_b64_tr_b16 v[40:41], v3 offset:57856
  ds_read_b64_tr_b16 v[42:43], v3 offset:59904
  ds_read_b64_tr_b16 v[44:45], v3 offset:61952
  ds_read_b64_tr_b16 v[46:47], v3 offset:64000
  s_waitcnt lgkmcnt(0)
  v_mfma_f32_16x16x32_bf16 v[192:195], v[16:19], v[80:83], v[192:195]
  v_mfma_f32_16x16x32_bf16 v[192:195], v[20:23], v[84:87], v[192:195]
  v_mfma_f32_16x16x32_bf16 v[196:199], v[16:19], v[88:91], v[196:199]
  v_mfma_f32_16x16x32_bf16 v[196:199], v[20:23], v[92:95], v[196:199]
  v_mfma_f32_16x16x32_bf16 v[200:203], v[16:19], v[96:99], v[200:203]
  v_mfma_f32_16x16x32_bf16 v[200:203], v[20:23], v[100:103], v[200:203]
  v_mfma_f32_16x16x32_bf16 v[204:207], v[16:19], v[104:107], v[204:207]
  v_mfma_f32_16x16x32_bf16 v[204:207], v[20:23], v[108:111], v[204:207]
  v_mfma_f32_16x16x32_bf16 v[208:211], v[24:27], v[80:83], v[208:211]
  v_mfma_f32_16x16x32_bf16 v[208:211], v[28:31], v[84:87], v[208:211]
  v_mfma_f32_16x16x32_bf16 v[212:215], v[24:27], v[88:91], v[212:215]
  v_mfma_f32_16x16x32_bf16 v[212:215], v[28:31], v[92:95], v[212:215]
  v_mfma_f32_16x16x32_bf16 v[216:219], v[24:27], v[96:99], v[216:219]
  v_mfma_f32_16x16x32_bf16 v[216:219], v[28:31], v[100:103], v[216:219]
  v_mfma_f32_16x16x32_bf16 v[220:223], v[24:27], v[104:107], v[220:223]
  v_mfma_f32_16x16x32_bf16 v[220:223], v[28:31], v[108:111], v[220:223]
  v_mfma_f32_16x16x32_bf16 v[224:227], v[32:35], v[80:83], v[224:227]
  v_mfma_f32_16x16x32_bf16 v[224:227], v[36:39], v[84:87], v[224:227]
  v_mfma_f32_16x16x32_bf16 v[228:231], v[32:35], v[88:91], v[228:231]
  v_mfma_f32_16x16x32_bf16 v[228:231], v[36:39], v[92:95], v[228:231]
  v_mfma_f32_16x16x32_bf16 v[232:235], v[32:35], v[96:99], v[232:235]
  v_mfma_f32_16x16x32_bf16 v[232:235], v[36:39], v[100:103], v[232:235]
  v_mfma_f32_16x16x32_bf16 v[236:239], v[32:35], v[104:107], v[236:239]
  v_mfma_f32_16x16x32_bf16 v[236:239], v[36:39], v[108:111], v[236:239]
  v_mfma_f32_16x16x32_bf16 v[240:243], v[40:43], v[80:83], v[240:243]
  v_mfma_f32_16x16x32_bf16 v[240:243], v[44:47], v[84:87], v[240:243]
  v_mfma_f32_16x16x32_bf16 v[244:247], v[40:43], v[88:91], v[244:247]
  v_mfma_f32_16x16x32_bf16 v[244:247], v[44:47], v[92:95], v[244:247]
  v_mfma_f32_16x16x32_bf16 v[248:251], v[40:43], v[96:99], v[248:251]
  v_mfma_f32_16x16x32_bf16 v[248:251], v[44:47], v[100:103], v[248:251]
  v_mfma_f32_16x16x32_bf16 v[252:255], v[40:43], v[104:107], v[252:255]
  v_mfma_f32_16x16x32_bf16 v[252:255], v[44:47], v[108:111], v[252:255]
  s_nop 7
  s_nop 3
  s_barrier
  s_sub_u32 s26, s26, 1
  s_cmp_lg_u32 s26, 0
  s_cbranch_scc1 L_p2
  s_branch L_fin
L_end:
  s_endpgm
L_codeend:
.section .rodata,"a"
.p2align 6
.amdhsa_kernel standalone__softmax_full_bidir__prompt_kernel
  .amdhsa_next_free_vgpr 512
  .amdhsa_next_free_sgpr 102
  .amdhsa_accum_offset 256
  .amdhsa_group_segment_fixed_size 0
  .amdhsa_kernarg_size 48
  .amdhsa_user_sgpr_count 2
  .amdhsa_user_sgpr_kernarg_segment_ptr 1
  .amdhsa_system_sgpr_workgroup_id_x 1
.end_amdhsa_kernel
```
